```python
import torch

def _softmax(x, axis=-1):
    return torch.softmax(x, dim=axis)
def _gelu(x):
    return torch.nn.functional.gelu(x, approximate="tanh")
def _silu(x):
    return torch.nn.functional.silu(x)
def _sigmoid(x):
    return torch.sigmoid(x)
def _layernorm(x, axis=-1, eps=1e-5):
    m = x.mean(dim=axis, keepdim=True)
    v = x.var(dim=axis, keepdim=True, unbiased=False)
    return (x - m) / torch.sqrt(v + eps)
def _scatter_add(tgt, idx, src, axis=0):
    return tgt.clone().index_add_(axis, idx, src)
def _segment_sum(src, seg, n):
    out = torch.zeros((n,) + src.shape[1:], dtype=src.dtype)
    return out.index_add_(0, seg, src)
def _pad(x, pw):
    flat = tuple(v for pair in reversed(pw) for v in pair)
    return torch.nn.functional.pad(x, flat)

kernel_name = 'standalone__cheap_equivariant_egnn__graph'

def setup_inputs():

    _w = (lambda a: (lambda t: t.to(torch.bfloat16) if t.is_floating_point() else t)(torch.as_tensor(a)))
    N, deg, D, De = 10000, 64, 64, max(16, 1)
    E = N * deg
    return {
        "h": _w((lambda *s: torch.randn(*s, dtype=torch.bfloat16) * 0.1)(N, D)),
        "pos": _w((lambda *s: torch.randn(*s, dtype=torch.bfloat16) * 0.8)(N, 3)),
        "e_attr": _w((lambda *s: torch.randn(*s, dtype=torch.bfloat16) * 0.8)(E, De)),
        "src": _w((lambda lo, hi, *s: torch.randint(lo, hi, s))(0, N, E).to(torch.int64)),
        "dst": _w((lambda lo, hi, *s: torch.randint(lo, hi, s))(0, N, E).to(torch.int64)),
        "w_e": _w(0.1 * (lambda *s: torch.randn(*s, dtype=torch.bfloat16) * 0.8)(2 * D + 1 + De, D)),
        "w_x": _w(0.1 * (lambda *s: torch.randn(*s, dtype=torch.bfloat16) * 0.1)(D, 1)),
        "w_h": _w(0.1 * (lambda *s: torch.randn(*s, dtype=torch.bfloat16) * 0.1)(2 * D, D)),
    }

def reference(h, pos, e_attr, src, dst, w_e, w_x, w_h):
    N, D = h.shape[0], h.shape[1]
    diff = pos[dst] - pos[src]
    dist2 = torch.sum(diff * diff, axis=-1, keepdims=True)
    e_in = torch.concatenate([h[dst], h[src], dist2, e_attr], axis=-1)
    m_ij = _silu(e_in @ w_e)
    coord_scale = m_ij @ w_x
    pos_new = pos + _segment_sum(diff * coord_scale, dst, N)
    m_i = _segment_sum(m_ij, dst, N)
    h_new = h + _silu(torch.concatenate([h, m_i], axis=-1) @ w_h)
    return h_new, pos_new
```

```asm
; @launch grid=(256,1,1) block=(512,1,1) lds=162304
.amdgcn_target "amdgcn-amd-amdhsa--gfx950"
.text
.globl standalone__cheap_equivariant_egnn__graph_kernel
.p2align 8
.type standalone__cheap_equivariant_egnn__graph_kernel,@function
standalone__cheap_equivariant_egnn__graph_kernel:
    s_load_dwordx4 s[28:31], s[0:1], 24
    s_load_dwordx2 s[24:25], s[0:1], 80
    s_getpc_b64 s[32:33]
K_PC:
    v_readfirstlane_b32 s96, v0
    v_lshlrev_b32 v100, 4, v0
    s_cmp_ge_u32 s2, 256
    s_cbranch_scc1 K_END
    s_lshl_b32 s96, s96, 4
    s_bfe_u32 s34, s2, 0x20003
    s_mul_i32 s94, s2, 10000
    v_add_u32 v101, s94, v100
    s_add_u32 s94, s94, 8192
    v_min_u32 v88, 451, v0
    v_lshl_add_u32 v88, v88, 2, s94
    s_lshr_b32 s3, s96, 10
    s_cbranch_scc1 K_NOCT
    s_mul_i32 s34, s34, 52
    v_min_u32 v2, 51, v0
    v_add_lshl_u32 v2, v2, s34, 7
    v_min_u32 v2, K_TAB-K_PC+16380, v2
    global_load_dword v38, v2, s[32:33]
K_NOCT:
    s_waitcnt lgkmcnt(0)
    global_load_dwordx4 v[52:55], v101, s[30:31]
    global_load_dword v56, v88, s[30:31]
    s_load_dwordx16 s[4:19], s[0:1], 0
    s_load_dwordx2 s[20:21], s[0:1], 64
    v_and_b32 v1, 63, v0
    v_mov_b32 v2, 0
    v_pk_mov_b32 v[84:85], 0, 0
    v_pk_mov_b32 v[86:87], 0, 0
    ds_write_b128 v100, v[84:87] offset:512
    ds_write_b128 v2, v[84:87] offset:32
    ds_write_b128 v2, v[84:87] offset:64
    ds_write_b128 v2, v[84:87] offset:80
    ds_write_b32 v2, v2 offset:33676
    s_and_b32 s95, s2, 7
    s_lshl_b32 s84, s95, 5
    s_lshr_b32 s99, s2, 3
    s_add_u32 s84, s84, s99
    s_mul_i32 s85, s84, 5000
    s_add_u32 s85, s85, 127
    s_lshr_b32 s85, s85, 7
    v_lshlrev_b32 v251, 4, v1
    v_xor_b32 v89, v100, v0
    v_and_b32 v89, 0x70, v89
    v_lshrrev_b32 v90, 3, v0
    v_lshl_or_b32 v89, v90, 7, v89
    v_add_u32 v109, 0x2000, v100
    s_add_u32 s62, s32, K_TAB-K_PC
    s_addc_u32 s63, s33, 0
    s_add_u32 m0, s96, 121856
    s_waitcnt lgkmcnt(0)
    s_barrier
    global_load_lds_dwordx4 v109, s[14:15]
    s_mov_b32 s40, s4
    s_mov_b32 s41, s5
    s_mov_b32 s42, 1280000
    s_mov_b32 s43, 0x20000
    s_mov_b32 s51, 0x20000
    s_cmp_ge_u32 s3, 5
    s_cbranch_scc1 K_TOUCH
    s_add_u32 m0, s96, 141312
    s_lshl_b32 s92, s85, 7
    buffer_load_dwordx4 v89, s[40:43], s92 offen lds
    s_add_u32 s89, s96, 16384
    s_cmp_eq_u32 s3, 3
    s_cselect_b32 s48, s16, s14
    s_cselect_b32 s49, s17, s15
    s_movk_i32 s50, 18560
    s_cselect_b32 s50, 128, s50
    s_cselect_b32 s89, 0, s89
    s_branch K_TOUCHED
K_TOUCH:
    s_mov_b32 s94, 60000
    s_cmp_eq_u32 s3, 6
    s_cselect_b32 s48, s14, s6
    s_cselect_b32 s49, s15, s7
    s_cselect_b32 s50, 18560, s94
    s_cmp_eq_u32 s3, 7
    s_cselect_b32 s48, s18, s48
    s_cselect_b32 s49, s19, s49
    s_cselect_b32 s50, 16384, s50
    s_lshl_b32 s92, s99, 11
    v_lshlrev_b32 v89, 7, v1
    s_mov_b64 exec, 0xffff
    buffer_load_dword v37, v89, s[48:51], s92 offen
    s_mov_b64 exec, -1
K_TOUCHED:
    global_load_dwordx4 v[58:61], v101, s[28:29]
    global_load_dword v62, v88, s[28:29]
    s_mov_b32 s92, 5308416
    s_load_dwordx2 s[26:27], s[24:25], s92
    v_cmp_gt_u32 vcc, 452, v0
    v_mov_b32 v104, 4
    v_lshlrev_b32 v141, 22, v0
    v_add_u32 v142, 0x100000, v141
    v_add_u32 v143, 0x200000, v141
    v_add_u32 v144, 0x300000, v141
    v_add_u32 v145, 0x800, v0
    v_lshlrev_b32 v145, 20, v145
    v_mov_b32 v107, 0x1ffc
    s_mov_b64 s[64:65], vcc
    s_lshl_b32 s66, 0xfe, s3
    s_and_b32 s66, s66, 0xff
    s_mov_b32 s67, 0
    s_mov_b32 s68, 429497
    s_mul_i32 s92, s2, 10240
    s_sub_u32 s92, s92, 2048
    v_add_u32 v101, s92, v100
    v_lshlrev_b32 v105, 2, v1
    s_lshl_b32 s92, s3, 2
    v_mov_b32 v106, s92
    s_lshl_b32 s98, s95, 2
    s_mul_i32 s92, s2, 80000
    v_lshl_add_u32 v111, v0, 7, s92
    v_lshrrev_b32 v139, 5, v1
    v_and_b32 v138, 3, v1
    s_and_b32 s92, s3, 1
    s_mul_i32 s92, s92, 10
    v_bfe_u32 v136, v1, 3, 2
    v_lshl_or_b32 v136, v136, 2, v138
    v_add_u32 v136, s92, v136
    v_xor_b32 v137, v136, v139
    v_and_b32 v137, 7, v137
    v_lshlrev_b32 v137, 4, v137
    v_lshl_or_b32 v136, v136, 8, v137
    v_bfe_u32 v137, v1, 2, 2
    v_lshlrev_b32 v137, 7, v137
    v_lshl_or_b32 v138, v138, 3, v137
    v_and_b32 v137, 0x80, v137
    s_mov_b32 s93, 141312
    v_add3_u32 v48, v136, v137, s93
    v_xor_b32 v49, 32, v48
    v_xor_b32 v50, 64, v48
    v_xor_b32 v51, 0x60, v48
    s_lshr_b32 s93, s3, 1
    s_cmp_eq_u32 s93, 0
    s_cselect_b32 s94, 8192, 0
    s_cmp_eq_u32 s93, 2
    s_cselect_b32 s94, 19456, s94
    s_mov_b32 s90, 0xbfb8aa3b
    s_cselect_b32 s60, 1.0, s90
    s_mov_b32 s61, s60
    s_add_u32 s94, s94, 113664
    v_and_b32 v137, 16, v1
    v_lshl_or_b32 v136, v137, 1, v138
    v_lshl_or_b32 v136, v139, 10, v136
    v_add_u32 v44, s94, v136
    s_lshl_b32 s92, s92, 8
    v_add_u32 v45, s92, v105
    s_add_u32 m0, s96, 33680
    s_nop 0
    global_load_lds_dwordx4 v100, s[62:63]
    s_add_u32 m0, s96, 41872
    s_nop 0
    global_load_lds_dwordx4 v109, s[62:63]
    s_waitcnt vmcnt(6)
    v_mul_u32_u24 v52, s68, v52
    v_mul_u32_u24 v53, s68, v53
    v_mul_u32_u24 v54, s68, v54
    v_mul_u32_u24 v55, s68, v55
    v_mul_u32_u24 v56, s68, v56
    v_lshrrev_b32 v64, 19, v52
    v_and_b32 v64, v107, v64
    v_lshrrev_b32 v65, 19, v53
    v_and_b32 v65, v107, v65
    v_lshrrev_b32 v66, 19, v54
    v_and_b32 v66, v107, v66
    v_lshrrev_b32 v67, 19, v55
    v_and_b32 v67, v107, v67
    v_lshrrev_b32 v68, 19, v56
    v_and_b32 v68, v107, v68
    ds_add_rtn_u32 v70, v64, v104 offset:512
    ds_add_rtn_u32 v71, v65, v104 offset:512
    ds_add_rtn_u32 v72, v66, v104 offset:512
    ds_add_rtn_u32 v73, v67, v104 offset:512
    s_mov_b64 exec, s[64:65]
    ds_add_rtn_u32 v74, v68, v104 offset:512
    s_mov_b64 exec, -1
    v_and_b32_sdwa v76, 28, v64 dst_sel:DWORD src0_sel:DWORD src1_sel:BYTE_1
    v_and_b32_sdwa v77, 28, v65 dst_sel:DWORD src0_sel:DWORD src1_sel:BYTE_1
    v_and_b32_sdwa v78, 28, v66 dst_sel:DWORD src0_sel:DWORD src1_sel:BYTE_1
    v_and_b32_sdwa v79, 28, v67 dst_sel:DWORD src0_sel:DWORD src1_sel:BYTE_1
    v_and_b32_sdwa v80, 28, v68 dst_sel:DWORD src0_sel:DWORD src1_sel:BYTE_1
    v_cmp_eq_u32 s[74:75], s98, v76
    v_cmp_eq_u32 s[76:77], s98, v77
    v_cmp_eq_u32 s[78:79], s98, v78
    v_cmp_eq_u32 s[80:81], s98, v79
    s_or_b64 s[74:75], s[74:75], s[76:77]
    s_or_b64 s[78:79], s[78:79], s[80:81]
    s_or_b64 s[80:81], s[74:75], s[78:79]
    v_and_b32 v148, 0x1fffff, v52
    v_and_b32 v149, 0x1fffff, v53
    v_and_b32 v150, 0x1fffff, v54
    v_and_b32 v151, 0x1fffff, v55
    v_and_b32 v152, 0x1fffff, v56
    s_waitcnt lgkmcnt(0)
    s_barrier
    ds_read_b128 v[84:87], v100 offset:512
    s_bitcmp1_b32 15, s3
    s_cselect_b64 exec, s[80:81], 0
    global_load_dword v240, v111, s[8:9]
    s_mov_b64 exec, -1
    s_add_u32 s26, s26, 0x7f4a7c15
    s_addc_u32 s27, s27, 0x9e3779b9
    v_mov_b32 v43, s26
    v_mul_u32_u24 v148, 0x4e2, v148
    v_mul_u32_u24 v149, 0x4e2, v149
    v_mul_u32_u24 v150, 0x4e2, v150
    v_mul_u32_u24 v151, 0x4e2, v151
    v_mul_u32_u24 v152, 0x4e2, v152
    v_lshrrev_b32 v148, 12, v148
    v_lshrrev_b32 v52, 7, v52
    v_lshrrev_b32 v149, 12, v149
    s_waitcnt lgkmcnt(0)
    v_add_u32 v88, v84, v85
    v_add_u32 v89, v88, v86
    v_add_u32 v90, v89, v87
    v_lshrrev_b32 v53, 7, v53
    v_lshrrev_b32 v150, 12, v150
    v_add_u32_dpp v91, v90, v90 row_shr:1 row_mask:0xf bank_mask:0xf bound_ctrl:0
    v_lshrrev_b32 v54, 7, v54
    v_lshrrev_b32 v151, 12, v151
    v_add_u32_dpp v91, v91, v91 row_shr:2 row_mask:0xf bank_mask:0xf
    v_lshrrev_b32 v55, 7, v55
    v_lshrrev_b32 v152, 12, v152
    v_add_u32_dpp v91, v91, v91 row_shr:4 row_mask:0xf bank_mask:0xf
    v_lshrrev_b32 v56, 7, v56
    v_and_b32 v148, 0xe0000, v148
    v_add_u32_dpp v91, v91, v91 row_shr:8 row_mask:0xf bank_mask:0xf
    v_and_b32 v52, 0x1c000, v52
    v_or_b32 v141, v141, v148
    v_add_u32_dpp v91, v91, v91 row_bcast:15 row_mask:0xa bank_mask:0xf
    v_and_b32 v149, 0xe0000, v149
    v_and_b32 v53, 0x1c000, v53
    v_add_u32_dpp v91, v91, v91 row_bcast:31 row_mask:0xc bank_mask:0xf
    v_sub_u32 v92, v91, v90
    v_readlane_b32 s92, v91, 63
    v_add_u32 v93, v92, v84
    v_add_u32 v94, v92, v88
    v_add_u32 v95, v92, v89
    v_mov_b32 v90, s92
    ds_write_b128 v100, v[92:95] offset:512
    s_mov_b64 exec, s[66:67]
    ds_add_u32 v105, v90 offset:64
    s_mov_b64 exec, -1
    v_mov_b32_dpp v40, v92 quad_perm:[0,0,2,2] row_mask:0xf bank_mask:0xf
    v_lshl_or_b32 v41, v94, 16, v93
    v_lshl_or_b32 v42, v91, 16, v95
    s_waitcnt vmcnt(5) lgkmcnt(0)
    s_barrier
    ds_read_b32 v76, v76 offset:64
    ds_read_b32 v77, v77 offset:64
    ds_read_b32 v78, v78 offset:64
    ds_read_b32 v79, v79 offset:64
    ds_read_b32 v80, v80 offset:64
    ds_read_b32 v64, v64 offset:512
    ds_read_b32 v65, v65 offset:512
    ds_read_b32 v66, v66 offset:512
    ds_read_b32 v67, v67 offset:512
    ds_read_b32 v68, v68 offset:512
    ds_read_b32 v106, v106 offset:64
    v_or_b32 v142, v142, v149
    v_and_b32 v150, 0xe0000, v150
    v_and_b32 v54, 0x1c000, v54
    v_or_b32 v143, v143, v150
    v_and_b32 v151, 0xe0000, v151
    v_and_b32 v55, 0x1c000, v55
    v_or_b32 v144, v144, v151
    v_and_b32 v152, 0xe0000, v152
    v_and_b32 v56, 0x1c000, v56
    v_or_b32 v145, v145, v152
    s_waitcnt vmcnt(3) lgkmcnt(6)
    v_bitop3_b32 v52, v52, v58, v141 bitop3:0xfe
    v_add_u32 v70, v70, v76
    v_bitop3_b32 v53, v53, v59, v142 bitop3:0xfe
    v_add_u32 v71, v71, v77
    v_bitop3_b32 v54, v54, v60, v143 bitop3:0xfe
    v_add_u32 v72, v72, v78
    v_bitop3_b32 v55, v55, v61, v144 bitop3:0xfe
    v_add_u32 v73, v73, v79
    v_bitop3_b32 v56, v56, v62, v145 bitop3:0xfe
    v_add_u32 v74, v74, v80
    s_waitcnt lgkmcnt(0)
    v_add_u32 v64, v64, v70
    v_add_u32 v65, v65, v71
    v_add_u32 v66, v66, v72
    v_add_u32 v67, v67, v73
    v_add_u32 v68, v68, v74
    ds_write_b32 v64, v52 offset:50064
    ds_write_b32 v65, v53 offset:50064
    ds_write_b32 v66, v54 offset:50064
    ds_write_b32 v67, v55 offset:50064
    s_mov_b64 exec, s[64:65]
    ds_write_b32 v68, v56 offset:50064
    s_mov_b64 exec, -1
    s_cmp_lt_u32 s3, 2
    s_cbranch_scc1 K_BTASK
    v_add_u32 v84, 0x1000, v101
    s_waitcnt vmcnt(1) lgkmcnt(0)
    s_barrier
    ds_read_b128 v[52:55], v100 offset:48016
    s_cmp_lt_u32 s3, 4
    s_cbranch_scc1 K_ONE
    ds_read_b128 v[58:61], v100 offset:52112
    s_waitcnt lgkmcnt(0)
    global_store_dwordx4 v84, v[58:61], s[24:25] sc1
K_ONE:
    s_waitcnt lgkmcnt(0)
    global_store_dwordx4 v101, v[52:55], s[24:25] sc1
    s_branch K_SHADOW
K_GEMM:
    ds_read_b128 v[180:183], v48
    ds_read_b64_tr_b16 v[196:197], v44 offset:0
    ds_read_b64_tr_b16 v[198:199], v44 offset:512
    ds_read_b128 v[184:187], v49
    ds_read_b64_tr_b16 v[200:201], v44 offset:2048
    ds_read_b64_tr_b16 v[202:203], v44 offset:2560
    ds_read_b128 v[188:191], v50
    ds_read_b64_tr_b16 v[204:205], v44 offset:4096
    ds_read_b64_tr_b16 v[206:207], v44 offset:4608
    ds_read_b128 v[192:195], v51
    ds_read_b64_tr_b16 v[208:209], v44 offset:6144
    ds_read_b64_tr_b16 v[210:211], v44 offset:6656
    s_add_u32 s64, s24, 6291456
    s_addc_u32 s65, s25, 0
    s_mov_b32 s66, 1280000
    s_mov_b32 s67, 0x20000
    s_waitcnt lgkmcnt(9)
    v_mfma_f32_32x32x16_bf16 v[116:131], v[180:183], v[196:199], 0
    ds_read_b64_tr_b16 v[212:213], v44 offset:64
    ds_read_b64_tr_b16 v[214:215], v44 offset:576
    s_waitcnt lgkmcnt(8)
    v_mfma_f32_32x32x16_bf16 v[116:131], v[184:187], v[200:203], v[116:131]
    ds_read_b64_tr_b16 v[216:217], v44 offset:2112
    ds_read_b64_tr_b16 v[218:219], v44 offset:2624
    s_waitcnt lgkmcnt(7)
    v_mfma_f32_32x32x16_bf16 v[116:131], v[188:191], v[204:207], v[116:131]
    ds_read_b64_tr_b16 v[220:221], v44 offset:4160
    ds_read_b64_tr_b16 v[222:223], v44 offset:4672
    s_waitcnt lgkmcnt(6)
    v_mfma_f32_32x32x16_bf16 v[116:131], v[192:195], v[208:211], v[116:131]
    ds_read_b64_tr_b16 v[224:225], v44 offset:6208
    ds_read_b64_tr_b16 v[226:227], v44 offset:6720
    s_waitcnt lgkmcnt(6)
    v_mfma_f32_32x32x16_bf16 v[84:99], v[180:183], v[212:215], 0
    s_waitcnt lgkmcnt(4)
    v_mfma_f32_32x32x16_bf16 v[84:99], v[184:187], v[216:219], v[84:99]
    s_cmp_ge_u32 s3, 2
    s_cbranch_scc1 K_NOBAR
    s_waitcnt vmcnt(1)
    s_barrier
K_NOBAR:
    s_waitcnt lgkmcnt(2)
    v_mfma_f32_32x32x16_bf16 v[84:99], v[188:191], v[220:223], v[84:99]
    s_waitcnt lgkmcnt(0)
    v_mfma_f32_32x32x16_bf16 v[84:99], v[192:195], v[224:227], v[84:99]
    s_lshl_b32 s92, s85, 7
    s_lshr_b32 s93, s3, 2
    s_mul_i32 s93, s93, 5120
    s_add_u32 s93, s93, 94208
    s_nop 2
    v_pk_mul_f32 v[116:117], v[116:117], s[60:61]
    v_pk_mul_f32 v[118:119], v[118:119], s[60:61]
    v_pk_mul_f32 v[120:121], v[120:121], s[60:61]
    v_pk_mul_f32 v[122:123], v[122:123], s[60:61]
    v_pk_mul_f32 v[124:125], v[124:125], s[60:61]
    v_pk_mul_f32 v[84:85], v[84:85], s[60:61]
    v_pk_mul_f32 v[86:87], v[86:87], s[60:61]
    v_pk_mul_f32 v[88:89], v[88:89], s[60:61]
    v_pk_mul_f32 v[90:91], v[90:91], s[60:61]
    v_pk_mul_f32 v[92:93], v[92:93], s[60:61]
    v_cvt_pk_bf16_f32 v116, v116, v84
    v_cvt_pk_bf16_f32 v117, v117, v85
    v_cvt_pk_bf16_f32 v118, v118, v86
    v_cvt_pk_bf16_f32 v119, v119, v87
    v_cvt_pk_bf16_f32 v120, v120, v88
    v_cvt_pk_bf16_f32 v121, v121, v89
    v_cvt_pk_bf16_f32 v122, v122, v90
    v_cvt_pk_bf16_f32 v123, v123, v91
    v_cvt_pk_bf16_f32 v124, v124, v92
    v_cvt_pk_bf16_f32 v125, v125, v93
    s_setpc_b64 s[62:63]
K_BTASK:
    s_call_b64 s[62:63], K_GEMM
    buffer_store_dword v116, v45, s[64:67], s92 offen offset:0 sc1
    buffer_store_dword v117, v45, s[64:67], s92 offen offset:256 sc1
    buffer_store_dword v118, v45, s[64:67], s92 offen offset:512 sc1
    buffer_store_dword v119, v45, s[64:67], s92 offen offset:768 sc1
    buffer_store_dword v120, v45, s[64:67], s92 offen offset:1024 sc1
    buffer_store_dword v121, v45, s[64:67], s92 offen offset:1280 sc1
    buffer_store_dword v122, v45, s[64:67], s92 offen offset:1536 sc1
    buffer_store_dword v123, v45, s[64:67], s92 offen offset:1792 sc1
    buffer_store_dword v124, v45, s[64:67], s92 offen offset:2048 sc1
    buffer_store_dword v125, v45, s[64:67], s92 offen offset:2304 sc1
K_SHADOW:
    s_add_u32 m0, s96, 113664
    s_nop 0
    global_load_lds_dwordx4 v100, s[14:15]
    v_pk_sub_u16 v41, v41, v40 op_sel_hi:[1,0]
    v_pk_sub_u16 v42, v42, v40 op_sel_hi:[1,0]
    s_mov_b32 s92, 0x00ff00ff
    s_mov_b32 s93, 0x06040200
    v_pk_min_u16 v41, v41, s92
    v_pk_min_u16 v42, v42, s92
    s_lshl_b32 s92, s27, 16
    v_add3_u32 v40, v40, v106, s92
    v_perm_b32 v42, v42, v41, s93
    v_lshlrev_b32 v106, 3, v1
    s_lshl_b32 s92, s2, 12
    s_lshr_b32 s93, s96, 1
    s_add_u32 s92, s92, s93
    s_add_u32 s92, s92, 3145728
    v_add_u32 v110, s92, v251
    ds_bpermute_b32 v40, v106, v40
    ds_bpermute_b32 v41, v106, v42
    ds_bpermute_b32 v42, v106, v42 offset:4
    ds_read_b128 v[136:139], v251 offset:46992
    ds_read_b128 v[232:235], v251 offset:49040
    ds_read_b128 v[228:231], v251 offset:48016
    ds_read_b128 v[32:35], v251 offset:39824
    ds_read_b128 v[132:135], v251 offset:45968
    ds_read_b128 v[248:251], v251 offset:44944
    ds_read_b128 v[12:15], v251 offset:34704
    ds_read_b128 v[28:31], v251 offset:38800
    ds_read_b128 v[8:11], v251 offset:33680
    ds_read_b128 v[16:19], v251 offset:35728
    ds_read_b128 v[20:23], v251 offset:36752
    ds_read_b128 v[24:27], v251 offset:37776
    s_mov_b32 s36, s6
    s_mov_b32 s37, s7
    s_mov_b32 s38, 60000
    s_mov_b32 s39, 0x20000
    s_add_u32 s28, s24, 6288384
    s_addc_u32 s29, s25, 8388608
    s_mov_b32 s30, 10000
    s_mov_b32 s31, 0x20000
    s_mov_b32 s32, s8
    s_or_b32 s33, s9, 1048576
    s_mov_b32 s34, 1280000
    s_mov_b32 s35, 0x20000
    s_mov_b32 s44, s20
    s_mov_b32 s45, s21
    s_mov_b32 s46, 1340000
    s_mov_b32 s47, 0x20000
    s_lshl_b32 s92, s3, 12
    s_add_u32 s52, s92, 113664
    s_mov_b32 s53, s52
    s_mul_i32 s54, s3, 1792
    s_add_u32 s54, s54, 146432
    s_mov_b32 s55, s54
    s_movk_i32 s56, 256
    s_mov_b32 s57, s56
    s_mov_b32 s58, 0x27800000
    s_mov_b32 s59, s58
    s_mov_b32 s4, 0x01000100
    s_mov_b32 s5, s4
    s_mov_b32 s13, s85
    s_mov_b32 s20, 0
    s_lshl_b32 s92, s84, 3
    s_add_u32 s92, s92, s3
    s_mul_i32 s92, s92, 625
    s_add_u32 s92, s92, 127
    s_lshr_b32 s92, s92, 7
    s_mul_i32 s92, s92, 6
    s_lshl_b32 s93, s3, 5
    s_or_b32 s94, s93, s95
    s_lshl_b32 s97, s84, 4
    s_add_u32 s97, s97, 3145728
    s_waitcnt lgkmcnt(9)
    v_add_u32 v139, s92, v139
    v_add_u32 v36, -2, v139
    v_xor_b32 v136, s94, v136
    v_xor_b32 v39, 4, v136
    buffer_load_ushort v230, v36, s[36:39], 0 offen
    buffer_load_ushort v231, v139, s[36:39], 0 offen
    ds_read_b128 v[156:159], v251 offset:40848
    ds_read_b128 v[160:163], v251 offset:41872
    ds_read_b128 v[172:175], v251 offset:42896
    ds_read_b128 v[176:179], v251 offset:43920
    s_add_u32 m0, s96, 133120
    s_nop 0
    global_load_lds_dwordx4 v100, s[18:19]
    v_lshl_add_u32 v144, v136, 12, s97
    v_lshl_add_u32 v145, v39, 12, s97
    v_mov_b32 v239, v137
    v_subrev_u32 v238, 0x10001, v137
    v_mul_u32_u24 v140, 2500, v136
    v_mul_u32_u24 v141, 2500, v39
    s_lshl_b32 s92, s99, 3
    s_add_u32 s92, s92, s3
    s_mul_i32 s92, s92, 40
    v_add_u32 v237, s92, v1
    s_mul_i32 s92, s3, 192
    v_add_u32 v138, s92, v138
    s_waitcnt lgkmcnt(8)
    s_movk_i32 s92, 10240
    v_mad_u32_u24 v142, v136, s92, v132
    v_mad_u32_u24 v143, v39, s92, v132
    v_mad_u32_u24 v152, v136, s92, v133
    v_mad_u32_u24 v153, v39, s92, v133
    s_mov_b32 exec_lo, 0x11111111
    s_mov_b32 exec_hi, 0x11111111
    v_mov_b32 v238, 0x0c000c0c
    s_mov_b64 exec, -1
    v_lshl_add_u64 v[12:13], v[12:13], 0, s[52:53]
    v_lshl_add_u64 v[14:15], v[14:15], 0, s[52:53]
    v_lshl_add_u64 v[28:29], v[28:29], 0, s[54:55]
    v_add_u32 v30, s54, v30
    s_lshl_b32 s92, s3, 2
    v_add_u32 v135, s92, v135
    s_lshl_b32 s92, s3, 9
    s_add_u32 s92, s92, 149504
    v_add_u32 v146, s92, v250
    v_and_b32 v147, -16, v146
    v_and_b32 v64, -16, v146
    v_mov_b32 v65, 0xe3fff
    s_and_b32 s92, s27, 0xffff
    v_mov_b32 v139, s92
    s_add_u32 m0, s96, 104448
    s_nop 0
    global_load_lds_dwordx4 v109, s[18:19]
    s_cmp_ge_u32 s3, 4
    s_cbranch_scc1 K_NOTAIL
    s_add_u32 m0, s96, 130048
    s_cmp_eq_u32 s3, 3
    s_cselect_b32 m0, 112640, m0
    s_nop 0
    buffer_load_dwordx4 v251, s[48:51], s89 offen lds
K_NOTAIL:
    s_mul_i32 s92, s3, 4112
    v_lshl_add_u32 v72, v1, 4, s92
    v_mov_b32 v68, 0xa2710
    v_mov_b32 v69, v68
    v_pk_mov_b32 v[70:71], v[68:69], v[68:69]
    v_lshlrev_b32 v73, 2, v1
    ds_write_b128 v72, v[68:71] offset:512
    ds_write_b128 v72, v[68:71] offset:1536
    ds_write_b128 v72, v[68:71] offset:2560
    ds_write_b128 v72, v[68:71] offset:3584
    ds_write_b32 v73, v2 offset:256
    s_sub_u32 s18, 11, s3
    s_cmp_lt_u32 s3, 4
    s_cselect_b32 s18, s3, s18
    s_mov_b32 s19, 0xe3fff
    s_mov_b32 exec_hi, 0
    s_waitcnt vmcnt(0) lgkmcnt(0)
    s_barrier
    global_store_dwordx4 v110, v[40:43], s[24:25] sc1
    s_mov_b32 exec_hi, -1
    s_bitcmp1_b32 192, s3
    s_cselect_b64 exec, s[80:81], 0
    global_load_dword v240, v111, s[8:9]
    s_mov_b64 exec, -1
    s_sub_u32 s92, s3, 2
    s_cmp_ge_u32 s92, 4
    s_cbranch_scc1 K_NOTASK
    s_call_b64 s[62:63], K_GEMM
    v_add_u32 v45, s93, v45
    ds_write2st64_b32 v45, v116, v117 offset0:0 offset1:1
    ds_write2st64_b32 v45, v118, v119 offset0:2 offset1:3
    ds_write2st64_b32 v45, v120, v121 offset0:4 offset1:5
    ds_write2st64_b32 v45, v122, v123 offset0:6 offset1:7
    ds_write2st64_b32 v45, v124, v125 offset0:8 offset1:9
    s_branch K_GEMMED
K_NOTASK:
    s_and_b32 s92, s96, 0xc00
    s_add_u32 s92, s92, 35840
K_POS_1:
    s_add_u32 m0, s92, 33680
    s_nop 0
    buffer_load_dwordx4 v251, s[36:39], s92 offen lds
    s_add_u32 s92, s92, 4096
    s_cmp_lt_u32 s92, 60416
    s_cbranch_scc1 K_POS_1
K_GEMMED:
K_POS_L:
    s_add_u32 m0, s96, 33680
    s_nop 0
    buffer_load_dwordx4 v251, s[36:39], s96 offen lds
    s_add_u32 s96, s96, 8192
    s_cmp_lt_u32 s96, 35840
    s_cbranch_scc1 K_POS_L
    global_load_dwordx4 v[100:103], v144, s[24:25] sc1
    global_load_dwordx4 v[104:107], v145, s[24:25] sc1
    v_lshlrev_b32 v230, 16, v230
    v_lshlrev_b32 v231, 16, v231
    v_fma_f32 v230, v230, v33, -v34
    s_mov_b32 exec_lo, 0x3f
    s_mov_b32 exec_hi, 0x3f
    ds_write_b128 v138, v[228:231]
    s_mov_b64 exec, -1
    ds_read_b64_tr_b16 v[164:165], v232 offset:0
    ds_read_b64_tr_b16 v[166:167], v232 offset:512
    ds_read_b64_tr_b16 v[168:169], v232 offset:32
    ds_read_b64_tr_b16 v[170:171], v232 offset:544
    ds_read_u16 v252, v233
    ds_read_u16 v253, v233 offset:32
    s_mov_b32 s60, s90
    s_mov_b32 s61, s90
    s_waitcnt lgkmcnt(2)
    v_lshlrev_b32 v46, 16, v164
    v_and_b32 v47, 0xffff0000, v164
    v_pk_mul_f32 v[46:47], v[46:47], s[60:61]
    v_cvt_pk_bf16_f32 v164, v46, v47
    v_lshlrev_b32 v46, 16, v165
    v_and_b32 v47, 0xffff0000, v165
    v_pk_mul_f32 v[46:47], v[46:47], s[60:61]
    v_cvt_pk_bf16_f32 v165, v46, v47
    v_lshlrev_b32 v46, 16, v166
    v_and_b32 v47, 0xffff0000, v166
    v_pk_mul_f32 v[46:47], v[46:47], s[60:61]
    v_cvt_pk_bf16_f32 v166, v46, v47
    v_lshlrev_b32 v46, 16, v167
    v_and_b32 v47, 0xffff0000, v167
    v_pk_mul_f32 v[46:47], v[46:47], s[60:61]
    v_cvt_pk_bf16_f32 v167, v46, v47
    v_lshlrev_b32 v46, 16, v168
    v_and_b32 v47, 0xffff0000, v168
    v_pk_mul_f32 v[46:47], v[46:47], s[60:61]
    v_cvt_pk_bf16_f32 v168, v46, v47
    v_lshlrev_b32 v46, 16, v169
    v_and_b32 v47, 0xffff0000, v169
    v_pk_mul_f32 v[46:47], v[46:47], s[60:61]
    v_cvt_pk_bf16_f32 v169, v46, v47
    v_lshlrev_b32 v46, 16, v170
    v_and_b32 v47, 0xffff0000, v170
    v_pk_mul_f32 v[46:47], v[46:47], s[60:61]
    v_cvt_pk_bf16_f32 v170, v46, v47
    v_lshlrev_b32 v46, 16, v171
    v_and_b32 v47, 0xffff0000, v171
    v_pk_mul_f32 v[46:47], v[46:47], s[60:61]
    v_cvt_pk_bf16_f32 v171, v46, v47
    s_mov_b32 s60, 0xbf317218
    s_waitcnt vmcnt(0)
K_OFFCHK:
    v_cmp_ne_u32 vcc, s26, v103
    v_cmp_ne_u32 s[92:93], s26, v107
    v_cmp_ne_u32_sdwa s[66:67], v139, v100 src0_sel:DWORD src1_sel:WORD_1
    v_cmp_ne_u32_sdwa s[64:65], v139, v104 src0_sel:DWORD src1_sel:WORD_1
    v_perm_b32 v148, v102, v101, v238
    v_perm_b32 v149, v102, v101, v239
    v_perm_b32 v150, v106, v105, v238
    v_perm_b32 v151, v106, v105, v239
    s_or_b64 vcc, vcc, s[92:93]
    s_or_b64 s[64:65], s[66:67], s[64:65]
    s_or_b64 vcc, vcc, s[64:65]
    s_cbranch_scc1 K_OFFRE
    v_add_u32_sdwa v142, v100, v142 dst_sel:DWORD src0_sel:WORD_0 src1_sel:DWORD
    v_add_u32_sdwa v152, v100, v152 dst_sel:DWORD src0_sel:WORD_0 src1_sel:DWORD
    v_sub_u32 v136, v149, v148
    v_add_u32_sdwa v143, v104, v143 dst_sel:DWORD src0_sel:WORD_0 src1_sel:DWORD
    v_add_u32_sdwa v153, v104, v153 dst_sel:DWORD src0_sel:WORD_0 src1_sel:DWORD
    v_sub_u32 v137, v151, v150
    v_cmp_lt_u32_sdwa s[64:65], v132, v102 src0_sel:DWORD src1_sel:BYTE_3
    v_cmp_lt_u32_sdwa s[72:73], v132, v106 src0_sel:DWORD src1_sel:BYTE_3
    s_mov_b64 exec, 0xffff
    ds_add_rtn_u32 v138, v134, v136 offset:256
    v_mov_b32 v136, 0
    s_mov_b64 exec, -1
    v_add_u32 v136, v136, v137
    v_sub_u32 v148, v148, v137
    ds_add_rtn_u32 v139, v135, v136 offset:256
    s_mov_b64 exec, s[64:65]
    global_load_dwordx4 v[52:55], v142, s[24:25] sc1
    s_mov_b64 exec, s[72:73]
    global_load_dwordx4 v[56:59], v143, s[24:25] sc1
    s_mov_b64 exec, -1
    v_sub_u32_sdwa v154, v102, v132 dst_sel:DWORD src0_sel:BYTE_3 src1_sel:DWORD
    v_sub_u32_sdwa v155, v106, v132 dst_sel:DWORD src0_sel:BYTE_3 src1_sel:DWORD
    v_sub_u32_sdwa v66, v102, v133 dst_sel:DWORD src0_sel:BYTE_3 src1_sel:DWORD
    v_sub_u32_sdwa v67, v106, v133 dst_sel:DWORD src0_sel:BYTE_3 src1_sel:DWORD
    v_max_i32 v136, v154, v155
    v_cmp_lt_i32 s[80:81], 64, v66
    v_cmp_lt_i32 s[82:83], 64, v67
    v_cmp_lt_i32 vcc, 0x50, v136
    s_mov_b64 exec, s[80:81]
    global_load_dword v60, v152, s[24:25] offset:64 sc1
    s_mov_b64 exec, s[82:83]
    global_load_dword v61, v153, s[24:25] offset:64 sc1
    s_mov_b64 exec, -1
    s_mov_b64 s[14:15], vcc
    s_cbranch_vccnz K_LONG
K_LONG_BACK:
    v_add_u32 v132, v132, v132
    v_add_u32 v133, v133, v133
    v_sub_u32 v148, v179, v148
    v_sub_u32 v149, v179, v149
    v_sub_u32 v150, v179, v150
    s_waitcnt lgkmcnt(0)
    s_barrier
    ds_read_b32 v40, v250 offset:256
    ds_read_b32 v137, v2 offset:32
    s_mov_b32 exec_lo, 0xfffff
    s_mov_b32 exec_hi, 0x0
    buffer_load_dword v243, v237, s[28:31], 0 idxen offset:3072 sc1
    s_mov_b64 exec, -1
    v_sub_u32 v149, v149, v138
    v_add_u32 v148, v148, v139
    v_add_u32 v150, v150, v139
    s_waitcnt lgkmcnt(0)
    v_add_u32_dpp v41, v40, v40 row_shr:1 row_mask:0xf bank_mask:0xf bound_ctrl:0
    v_cmp_lt_i32 s[66:67], 4, v154
    v_cmp_lt_i32 s[68:69], 8, v154
    v_add_u32_dpp v41, v41, v41 row_shr:2 row_mask:0xf bank_mask:0xf
    v_cmp_lt_i32 s[70:71], 12, v154
    v_cmp_lt_i32 s[74:75], 4, v155
    v_add_u32_dpp v41, v41, v41 row_shr:4 row_mask:0xf bank_mask:0xf
    v_cmp_lt_i32 s[76:77], 8, v155
    v_cmp_lt_i32 s[78:79], 12, v155
    v_add_u32_dpp v41, v41, v41 row_shr:8 row_mask:0xf bank_mask:0xf
    v_sub_u32 v42, v41, v40
    ds_bpermute_b32 v42, v135, v42
    ds_bpermute_b32 v138, v172, v41
    ds_bpermute_b32 v139, v173, v41
    v_cndmask_b32 v43, v41, v40, s[4:5]
    v_pk_sub_u16 v43, v43, v178 clamp
    v_or_b32 v43, v43, v137
    v_cmp_ne_u32 vcc, 0, v43
    s_cmp_lg_u64 vcc, 0
    s_cselect_b32 s86, 5, 0
    s_waitcnt lgkmcnt(0)
    v_add_u32 v148, v148, v42
    v_add_lshl_u32 v150, v150, v42, 1
    s_nop 0
    v_mov_b32_dpp v148, v149 quad_perm:[0,1,2,3] row_mask:0x1 bank_mask:0xf
    v_add_u32 v148, v148, v148
    ds_write2st64_b32 v146, v148, v150 offset1:1
    v_bfe_u32 v138, v138, v174, 16
    v_bfe_u32 v139, v139, v175, 16
    v_lshl_add_u32 v138, v138, 1, v176
    v_lshl_add_u32 v139, v139, 1, v177
    v_cmp_gt_u32 vcc, v139, v138
    s_lshl_b32 s92, s3, 3
    s_lshl_b32 s94, s84, 3
    v_lshrrev_b64 v[148:149], v9, vcc
    v_and_b32 v148, 0xff, v148
    v_bcnt_u32_b32 v148, v148, 0
    v_cmp_eq_u32 vcc, s18, v148
    s_ff1_i32_b64 s89, vcc
    s_cmp_lg_u32 s86, 0
    s_cselect_b32 s89, s92, s89
    s_or_b32 s92, s89, 8
    s_lshl_b32 s93, s89, 1
    v_readlane_b32 s21, v138, s89
    v_readlane_b32 s10, v40, s92
    s_lshr_b32 s89, s89, 3
    s_add_u32 s92, s94, s89
    s_mul_i32 s91, s92, 625
    s_add_u32 s85, s91, 127
    s_lshr_b32 s85, s85, 7
    s_lshr_b32 s10, s10, s93
    s_and_b32 s10, s10, 0xffff
    s_mul_i32 s92, s89, 192
    v_add_u32 v31, s92, v31
    s_cmp_lg_u32 s86, 0
    s_cbranch_scc1 K_SLOW_INIT
    s_waitcnt vmcnt(1)
    v_lshrrev_b32 v68, 13, v52
    v_bitop3_b32 v68, v68, 14, v147 bitop3:0xea
    v_lshrrev_b32 v69, 13, v53
    v_bitop3_b32 v69, v69, 14, v147 bitop3:0xea
    v_lshrrev_b32 v70, 13, v54
    v_bitop3_b32 v70, v70, 14, v147 bitop3:0xea
    v_lshrrev_b32 v71, 13, v55
    v_bitop3_b32 v71, v71, 14, v64 bitop3:0xea
    v_lshrrev_b32 v72, 13, v56
    v_bitop3_b32 v72, v72, 14, v147 bitop3:0xea
    v_lshrrev_b32 v73, 13, v57
    v_bitop3_b32 v73, v73, 14, v147 bitop3:0xea
    v_lshrrev_b32 v74, 13, v58
    v_bitop3_b32 v74, v74, 14, v147 bitop3:0xea
    v_lshrrev_b32 v75, 13, v59
    v_bitop3_b32 v75, v75, 14, v64 bitop3:0xea
    v_lshrrev_b32 v76, 13, v60
    v_bitop3_b32 v76, v76, 14, v147 bitop3:0xea
    v_lshrrev_b32 v77, 13, v61
    v_bitop3_b32 v77, v77, 14, v147 bitop3:0xea
    ds_read_u16 v68, v68 offset:0
    ds_read_u16 v69, v69 offset:0
    ds_read_u16 v70, v70 offset:0
    ds_read_u16 v71, v71 offset:0
    ds_read_u16 v72, v72 offset:256
    ds_read_u16 v73, v73 offset:256
    ds_read_u16 v74, v74 offset:256
    ds_read_u16 v75, v75 offset:256
    ds_read_u16 v76, v76 offset:0
    ds_read_u16 v77, v77 offset:256
    v_lshrrev_b32 v85, 20, v52
    v_add_u32 v85, v140, v85
    v_and_b32 v84, v65, v52
    v_lshrrev_b32 v87, 20, v53
    v_add_u32 v87, v140, v87
    v_and_b32 v86, v65, v53
    v_lshrrev_b32 v89, 20, v54
    v_add_u32 v89, v140, v89
    v_and_b32 v88, v65, v54
    v_lshrrev_b32 v91, 20, v55
    v_add_u32 v91, v140, v91
    v_and_b32 v90, v65, v55
    v_lshrrev_b32 v93, 20, v56
    v_add_u32 v93, v141, v93
    v_and_b32 v92, v65, v56
    s_waitcnt lgkmcnt(0)
    v_add_u32 v68, v68, v132
    v_add_u32 v69, v69, v132
    v_add_u32 v70, v70, v132
    v_add_u32 v71, v71, v132
    v_add_u32 v72, v72, v132
    s_mov_b64 exec, s[64:65]
    ds_write_b64 v68, v[84:85] offset:256
    s_mov_b64 exec, s[66:67]
    ds_write_b64 v69, v[86:87] offset:264
    s_mov_b64 exec, s[68:69]
    ds_write_b64 v70, v[88:89] offset:272
    s_mov_b64 exec, s[70:71]
    ds_write_b64 v71, v[90:91] offset:280
    s_mov_b64 exec, s[72:73]
    ds_write_b64 v72, v[92:93] offset:256
    s_mov_b64 exec, -1
    v_lshrrev_b32 v95, 20, v57
    v_add_u32 v95, v141, v95
    v_and_b32 v94, v65, v57
    v_lshrrev_b32 v97, 20, v58
    v_add_u32 v97, v141, v97
    v_and_b32 v96, v65, v58
    v_lshrrev_b32 v99, 20, v59
    v_add_u32 v99, v141, v99
    v_and_b32 v98, v65, v59
    v_lshrrev_b32 v101, 20, v60
    v_add_u32 v101, v140, v101
    v_and_b32 v100, v65, v60
    v_lshrrev_b32 v103, 20, v61
    v_add_u32 v103, v141, v103
    v_and_b32 v102, v65, v61
    v_add_u32 v73, v73, v132
    v_add_u32 v74, v74, v132
    v_add_u32 v75, v75, v132
    v_add_u32 v76, v76, v133
    v_add_u32 v77, v77, v133
    s_mov_b64 exec, s[74:75]
    ds_write_b64 v73, v[94:95] offset:264
    s_mov_b64 exec, s[76:77]
    ds_write_b64 v74, v[96:97] offset:272
    s_mov_b64 exec, s[78:79]
    ds_write_b64 v75, v[98:99] offset:280
    s_mov_b64 exec, s[80:81]
    ds_write_b64 v76, v[100:101] offset:384
    s_mov_b64 exec, s[82:83]
    ds_write_b64 v77, v[102:103] offset:384
    s_mov_b64 exec, -1
    s_cmp_lg_u64 s[14:15], 0
    s_cbranch_scc1 K_R2
K_PAIRING:
K_PROCESS:
    s_mul_i32 s92, s89, 4112
    s_sub_u32 s93, 384, s10
    s_lshl1_add_u32 s92, s93, s92
    v_add_u32 v5, s92, v9
    v_add_u32 v4, s92, v8
    s_add_u32 s22, s21, 248
    s_bitcmp1_b32 s86, 3
    s_cbranch_scc1 K_PP
    s_waitcnt vmcnt(1) lgkmcnt(0)
    s_barrier
K_PP:
    ds_read_b64 v[36:37], v4 offset:512
    ds_read_u16 v16, v5 offset:512
    ds_read_u16 v18, v5 offset:576
    ds_read_u16 v20, v5 offset:640
    ds_read_u16 v22, v5 offset:704
    ds_write2_b32 v30, v2, v2 offset0:0 offset1:1
    ds_write2_b32 v30, v2, v2 offset0:2 offset1:3
    ds_write2_b32 v30, v2, v2 offset0:4 offset1:5
    ds_write_b32 v30, v2 offset:24
    s_setprio 3
    s_waitcnt lgkmcnt(4)
    v_lshl_add_u32 v24, v37, 1, v25
    buffer_load_dwordx4 v[48:51], v24, s[32:35], 0 idxen
    s_mov_b32 m0, s52
    s_nop 0
    buffer_load_dwordx4 v[16:17], s[28:31], 0 idxen offen offset:0 sc1 lds
    buffer_load_dwordx4 v[18:19], s[28:31], 0 idxen offen offset:1024 sc1 lds
    buffer_load_dwordx4 v[20:21], s[28:31], 0 idxen offen offset:2048 sc1 lds
    buffer_load_dwordx4 v[22:23], s[28:31], 0 idxen offen offset:3072 sc1 lds
    s_setprio 0
    v_mad_u32_u16 v37, v36, 6, v32
    v_mad_u32_u16 v38, v36, 8, v31 op_sel:[1,0,0,0]
    v_mad_u32_u16 v39, v36, 4, v29 op_sel:[1,0,0,0]
    v_pk_mov_b32 v[240:241], 0, 0
    v_pk_mov_b32 v[148:149], 0, 0
    v_pk_mov_b32 v[150:151], 0, 0
    v_pk_mov_b32 v[152:153], 0, 0
    v_pk_mov_b32 v[154:155], 0, 0
    ds_read_u16_d16_hi v240, v37 offset:33678
    ds_read_u16_d16_hi v241, v37 offset:33680
    ds_read_b128 v[40:43], v38
    ds_read_u16 v16, v5 offset:768
    ds_read_u16 v18, v5 offset:832
    ds_read_u16 v20, v5 offset:896
    ds_read_u16 v22, v5 offset:960
    s_bfe_u32 s12, s22, 0x20006
    s_lshr_b32 s87, s22, 8
    s_bitcmp1_b32 s86, 1
    s_cbranch_scc1 K_KEEP
    s_sub_u32 s92, s85, s13
    s_lshl_b32 s92, s92, 7
    v_add_u32 v136, s92, v35
    s_add_u32 s92, s92, 99328
    v_add_u32 v137, s92, v250
    ds_read_u16 v116, v136 offset:0
    ds_read_u16 v117, v136 offset:256
    ds_read_u16 v118, v136 offset:512
    ds_read_u16 v119, v136 offset:64
    ds_read_u16 v120, v136 offset:320
    ds_read_u16 v121, v136 offset:576
    ds_read_b32 v228, v137 offset:0
    ds_read_b32 v229, v137 offset:256
    ds_read_b32 v230, v137 offset:512
    v_mov_b32 v6, v235
    ds_read_b64_tr_b16 v[180:181], v234 offset:0
    ds_read_b64_tr_b16 v[182:183], v234 offset:1024
    ds_read_b64_tr_b16 v[184:185], v234 offset:64
    ds_read_b64_tr_b16 v[186:187], v234 offset:1088
    ds_read_b64_tr_b16 v[188:189], v234 offset:4096
    ds_read_b64_tr_b16 v[190:191], v234 offset:5120
    ds_read_b64_tr_b16 v[192:193], v234 offset:4160
    ds_read_b64_tr_b16 v[194:195], v234 offset:5184
    ds_read_b64_tr_b16 v[196:197], v234 offset:2048
    ds_read_b64_tr_b16 v[198:199], v234 offset:3072
    ds_read_b64_tr_b16 v[200:201], v234 offset:2112
    ds_read_b64_tr_b16 v[202:203], v234 offset:3136
    ds_read_b64_tr_b16 v[204:205], v234 offset:6144
    ds_read_b64_tr_b16 v[206:207], v234 offset:7168
    ds_read_b64_tr_b16 v[208:209], v234 offset:6208
    ds_read_b64_tr_b16 v[210:211], v234 offset:7232
    v_mfma_f32_32x32x8_bf16 v[84:99], v[148:149], v[148:149], 0
    s_lshl_b32 s92, s85, 7
    v_add_u32 v248, s92, v248
    s_mul_i32 s92, s85, 3
    s_sub_u32 s92, s92, 1
    v_add_lshl_u32 v249, v249, s92, 1
    s_add_u32 s91, s91, 752
    s_lshr_b32 s91, s91, 7
    s_sub_u32 s91, s91, s85
    v_pk_mov_b32 v[122:123], 0, 0
    v_pk_mov_b32 v[234:235], 0, 0
    v_pk_mov_b32 v[236:237], 0, 0
    v_pk_mov_b32 v[238:239], 0, 0
    v_mov_b32 v242, 0
    v_mfma_f32_32x32x8_bf16 v[100:115], v[148:149], v[148:149], 0
    s_waitcnt lgkmcnt(0)
    v_and_b32 v231, 0xffff0000, v228
    v_and_b32 v232, 0xffff0000, v229
    v_and_b32 v233, 0xffff0000, v230
    v_lshlrev_b32 v228, 16, v228
    v_lshlrev_b32 v229, 16, v229
    v_lshlrev_b32 v230, 16, v230
    v_lshl_or_b32 v244, v117, 16, v116
    v_lshl_or_b32 v245, v252, 16, v118
    v_lshl_or_b32 v246, v120, 16, v119
    v_lshl_or_b32 v247, v253, 16, v121
K_KEEP:
    v_pk_mov_b32 v[124:125], 0, 0
    v_pk_mov_b32 v[126:127], 0, 0
    v_pk_mov_b32 v[172:173], 0, 0
    v_pk_mov_b32 v[174:175], 0, 0
    v_pk_mov_b32 v[176:177], 0, 0
    v_pk_mov_b32 v[178:179], 0, 0
    v_mov_b32 v252, 1.0
    v_mov_b32 v253, 1.0
    s_waitcnt lgkmcnt(0)
    ds_read_b64 v[36:37], v4 offset:768
    v_pk_fma_f32 v[42:43], v[240:241], v[10:11], v[42:43]
    v_pk_mul_f32 v[250:251], v[42:43], v[26:27]
    v_cvt_pk_bf16_f32 v3, v250, v251
    v_fma_f32 v42, v42, v42, v34
    v_fmac_f32 v42, v43, v43
    v_mul_f32 v42, s90, v42
    v_cvt_pk_bf16_f32 v41, v41, v42
    ds_write_b32 v39, v3
    s_cmp_lg_u32 s86, 0
    s_cselect_b32 s92, 64, 2
    v_mfma_f32_32x32x8_bf16 v[52:67], v[40:41], v[244:245], 0
    s_cmp_gt_u32 s87, 2
    s_cselect_b32 s11, 2, 1
    s_cmp_gt_u32 s87, 4
    s_cselect_b32 s11, 4, s11
    s_waitcnt vmcnt(0)
    ds_read_b128 v[132:135], v12
    ds_read_b128 v[136:139], v13
    ds_read_b128 v[140:143], v14
    ds_read_b128 v[144:147], v15
    s_setprio 3
    v_mfma_f32_32x32x16_bf16 v[52:67], v[48:51], v[164:167], v[52:67]
    s_waitcnt lgkmcnt(2)
    v_mfma_f32_32x32x16_bf16 v[52:67], v[132:135], v[156:159], v[52:67]
    v_mfma_f32_32x32x16_bf16 v[52:67], v[136:139], v[160:163], v[52:67]
    s_waitcnt lgkmcnt(0)
    buffer_load_dwordx4 v[16:17], s[28:31], 0 idxen offen offset:0 sc1 lds
    buffer_load_dwordx4 v[18:19], s[28:31], 0 idxen offen offset:1024 sc1 lds
    buffer_load_dwordx4 v[20:21], s[28:31], 0 idxen offen offset:2048 sc1 lds
    buffer_load_dwordx4 v[22:23], s[28:31], 0 idxen offen offset:3072 sc1 lds
    ds_read_u16 v16, v5 offset:1024
    ds_read_u16 v18, v5 offset:1088
    ds_read_u16 v20, v5 offset:1152
    ds_read_u16 v22, v5 offset:1216
    s_cmp_lt_u32 s87, s92
    s_cbranch_scc1 K_SHORT
.p2align 3
K_LOOP:
    v_mfma_f32_32x32x16_bf16 v[68:83], v[48:51], v[168:171], 0
    v_exp_f32 v44, v52
    v_exp_f32 v45, v53
    v_exp_f32 v46, v54
    v_mfma_f32_32x32x16_bf16 v[68:83], v[140:143], v[156:159], v[68:83]
    v_lshl_add_u32 v24, v37, 1, v25
    v_mad_u32_u16 v37, v36, 6, v32
    v_exp_f32 v47, v55
    v_rcp_f32 v252, v252
    v_rcp_f32 v253, v253
    v_cvt_pk_bf16_f32 v128, v176, v177
    v_cvt_pk_bf16_f32 v129, v178, v179
    v_pk_mul_f32 v[176:177], v[172:173], v[252:253]
    v_pk_mul_f32 v[178:179], v[174:175], v[252:253]
    v_pk_fma_f32 v[44:45], v[44:45], s[58:59], s[58:59]
    v_pk_fma_f32 v[172:173], v[52:53], v[46:47], v[52:53]
    v_pk_fma_f32 v[252:253], v[44:45], v[46:47], v[44:45]
    v_pk_mul_f32 v[174:175], v[54:55], v[44:45]
    v_mfma_f32_32x32x16_bf16 v[68:83], v[144:147], v[160:163], v[68:83]
    v_exp_f32 v44, v56
    v_exp_f32 v45, v57
    v_exp_f32 v46, v58
    v_mfma_f32_32x32x16_bf16 v[100:115], v[124:127], v[148:151], v[100:115]
    v_lshl_add_u64 v[4:5], v[4:5], 0, s[56:57]
    v_mad_u32_u16 v38, v36, 8, v31 op_sel:[1,0,0,0]
    v_exp_f32 v47, v59
    v_rcp_f32 v252, v252
    v_rcp_f32 v253, v253
    v_cvt_pk_bf16_f32 v130, v176, v177
    v_cvt_pk_bf16_f32 v131, v178, v179
    v_pk_mul_f32 v[176:177], v[172:173], v[252:253]
    v_pk_mul_f32 v[178:179], v[174:175], v[252:253]
    v_pk_fma_f32 v[44:45], v[44:45], s[58:59], s[58:59]
    v_pk_fma_f32 v[172:173], v[56:57], v[46:47], v[56:57]
    v_pk_fma_f32 v[252:253], v[44:45], v[46:47], v[44:45]
    v_pk_mul_f32 v[174:175], v[58:59], v[44:45]
    v_mfma_f32_32x32x8_bf16 v[68:83], v[40:41], v[246:247], v[68:83]
    v_exp_f32 v44, v60
    v_exp_f32 v45, v61
    v_exp_f32 v46, v62
    v_exp_f32 v47, v63
    v_rcp_f32 v252, v252
    v_rcp_f32 v253, v253
    v_cvt_pk_bf16_f32 v116, v176, v177
    v_cvt_pk_bf16_f32 v117, v178, v179
    v_pk_mul_f32 v[176:177], v[172:173], v[252:253]
    v_pk_mul_f32 v[178:179], v[174:175], v[252:253]
    v_pk_fma_f32 v[44:45], v[44:45], s[58:59], s[58:59]
    v_pk_fma_f32 v[172:173], v[60:61], v[46:47], v[60:61]
    v_pk_fma_f32 v[252:253], v[44:45], v[46:47], v[44:45]
    v_pk_mul_f32 v[174:175], v[62:63], v[44:45]
    v_mfma_f32_32x32x16_bf16 v[100:115], v[128:131], v[152:155], v[100:115]
    buffer_load_dwordx4 v[48:51], v24, s[32:35], 0 idxen
    s_waitcnt vmcnt(1)
    ds_read_u16_d16_hi v240, v37 offset:33678
    ds_read_u16_d16_hi v241, v37 offset:33680
    ds_read_b128 v[40:43], v38
    ds_read_b128 v[132:135], v12
    ds_read_b128 v[136:139], v13
    ds_read_b128 v[140:143], v14
    ds_read_b128 v[144:147], v15
    ds_read_b64_tr_b16 v[148:149], v28 offset:0
    ds_read_b64_tr_b16 v[150:151], v28 offset:448
    ds_read_b64_tr_b16 v[152:153], v28 offset:896
    ds_read_b64_tr_b16 v[154:155], v28 offset:1344
    ds_write_b32 v39, v2
    v_exp_f32 v44, v64
    v_exp_f32 v45, v65
    v_exp_f32 v46, v66
    v_exp_f32 v47, v67
    v_rcp_f32 v252, v252
    v_rcp_f32 v253, v253
    v_cvt_pk_bf16_f32 v118, v176, v177
    v_cvt_pk_bf16_f32 v119, v178, v179
    v_pk_mul_f32 v[176:177], v[172:173], v[252:253]
    v_pk_mul_f32 v[178:179], v[174:175], v[252:253]
    v_pk_fma_f32 v[44:45], v[44:45], s[58:59], s[58:59]
    v_pk_fma_f32 v[172:173], v[64:65], v[46:47], v[64:65]
    v_pk_fma_f32 v[252:253], v[44:45], v[46:47], v[44:45]
    v_pk_mul_f32 v[174:175], v[66:67], v[44:45]
    s_waitcnt lgkmcnt(8)
    v_pk_fma_f32 v[42:43], v[240:241], v[10:11], v[42:43]
    v_pk_mul_f32 v[250:251], v[42:43], v[26:27]
    v_mfma_f32_32x32x16_bf16 v[52:67], v[132:135], v[156:159], 0
    v_mad_u32_u16 v39, v36, 4, v29 op_sel:[1,0,0,0]
    v_cvt_pk_bf16_f32 v3, v250, v251
    v_exp_f32 v44, v68
    v_exp_f32 v45, v69
    v_exp_f32 v46, v70
    s_waitcnt lgkmcnt(5)
    ds_write_b32 v39, v3
    buffer_load_dwordx4 v[16:17], s[28:31], 0 idxen offen offset:0 sc1 lds
    buffer_load_dwordx4 v[18:19], s[28:31], 0 idxen offen offset:1024 sc1 lds
    buffer_load_dwordx4 v[20:21], s[28:31], 0 idxen offen offset:2048 sc1 lds
    buffer_load_dwordx4 v[22:23], s[28:31], 0 idxen offen offset:3072 sc1 lds
    ds_read_b64 v[36:37], v4 offset:768
    ds_read_u16 v16, v5 offset:1024
    ds_read_u16 v18, v5 offset:1088
    ds_read_u16 v20, v5 offset:1152
    ds_read_u16 v22, v5 offset:1216
    s_sub_u32 s87, s87, 1
    s_cmp_lg_u32 s87, s11
    v_exp_f32 v47, v71
    v_rcp_f32 v252, v252
    v_rcp_f32 v253, v253
    v_cvt_pk_bf16_f32 v120, v176, v177
    v_cvt_pk_bf16_f32 v121, v178, v179
    v_pk_mul_f32 v[176:177], v[172:173], v[252:253]
    v_pk_mul_f32 v[178:179], v[174:175], v[252:253]
    v_pk_fma_f32 v[44:45], v[44:45], s[58:59], s[58:59]
    v_pk_fma_f32 v[172:173], v[68:69], v[46:47], v[68:69]
    v_pk_fma_f32 v[252:253], v[44:45], v[46:47], v[44:45]
    v_pk_mul_f32 v[174:175], v[70:71], v[44:45]
    v_mfma_f32_32x32x16_bf16 v[52:67], v[136:139], v[160:163], v[52:67]
    v_fma_f32 v42, v42, v42, v34
    v_fmac_f32 v42, v43, v43
    v_exp_f32 v44, v72
    v_exp_f32 v45, v73
    v_exp_f32 v46, v74
    s_waitcnt lgkmcnt(7)
    v_mfma_f32_32x32x16_bf16 v[84:99], v[116:119], v[148:151], v[84:99]
    v_mul_f32 v42, s90, v42
    v_cvt_pk_bf16_f32 v41, v41, v42
    v_exp_f32 v47, v75
    v_rcp_f32 v252, v252
    v_rcp_f32 v253, v253
    v_cvt_pk_bf16_f32 v122, v176, v177
    v_cvt_pk_bf16_f32 v123, v178, v179
    v_pk_mul_f32 v[176:177], v[172:173], v[252:253]
    v_pk_mul_f32 v[178:179], v[174:175], v[252:253]
    v_pk_fma_f32 v[44:45], v[44:45], s[58:59], s[58:59]
    v_pk_fma_f32 v[172:173], v[72:73], v[46:47], v[72:73]
    v_pk_fma_f32 v[252:253], v[44:45], v[46:47], v[44:45]
    v_pk_mul_f32 v[174:175], v[74:75], v[44:45]
    v_mfma_f32_32x32x8_bf16 v[52:67], v[40:41], v[244:245], v[52:67]
    v_exp_f32 v44, v76
    v_exp_f32 v45, v77
    v_exp_f32 v46, v78
    v_mfma_f32_32x32x16_bf16 v[84:99], v[120:123], v[152:155], v[84:99]
    v_exp_f32 v47, v79
    v_rcp_f32 v252, v252
    v_rcp_f32 v253, v253
    v_cvt_pk_bf16_f32 v124, v176, v177
    v_cvt_pk_bf16_f32 v125, v178, v179
    v_pk_mul_f32 v[176:177], v[172:173], v[252:253]
    v_pk_mul_f32 v[178:179], v[174:175], v[252:253]
    v_pk_fma_f32 v[44:45], v[44:45], s[58:59], s[58:59]
    v_pk_fma_f32 v[172:173], v[76:77], v[46:47], v[76:77]
    v_pk_fma_f32 v[252:253], v[44:45], v[46:47], v[44:45]
    v_pk_mul_f32 v[174:175], v[78:79], v[44:45]
    s_waitcnt vmcnt(4) lgkmcnt(0)
    v_mfma_f32_32x32x16_bf16 v[52:67], v[48:51], v[164:167], v[52:67]
    v_exp_f32 v44, v80
    v_exp_f32 v45, v81
    v_exp_f32 v46, v82
    v_exp_f32 v47, v83
    v_rcp_f32 v252, v252
    v_rcp_f32 v253, v253
    v_cvt_pk_bf16_f32 v126, v176, v177
    v_cvt_pk_bf16_f32 v127, v178, v179
    v_pk_mul_f32 v[176:177], v[172:173], v[252:253]
    v_pk_mul_f32 v[178:179], v[174:175], v[252:253]
    v_pk_fma_f32 v[44:45], v[44:45], s[58:59], s[58:59]
    v_pk_fma_f32 v[172:173], v[80:81], v[46:47], v[80:81]
    v_pk_fma_f32 v[252:253], v[44:45], v[46:47], v[44:45]
    v_pk_mul_f32 v[174:175], v[82:83], v[44:45]
    s_cbranch_scc1 K_LOOP
    s_cmp_lg_u32 s87, 1
    s_cbranch_scc1 K_STAGE
K_TAIL:
    s_setprio 0
    buffer_load_short_d16_hi v234, v248, s[40:43], 0 offen offset:0
    buffer_load_short_d16_hi v237, v248, s[40:43], 0 offen offset:64
    buffer_load_short_d16_hi v235, v248, s[40:43], 0 offen offset:256
    buffer_load_short_d16_hi v238, v248, s[40:43], 0 offen offset:320
    buffer_load_short_d16_hi v236, v248, s[40:43], 0 offen offset:512
    buffer_load_short_d16_hi v239, v248, s[40:43], 0 offen offset:576
    buffer_load_short_d16_hi v242, v249, s[36:39], 0 offen
    v_mfma_f32_32x32x8_bf16 v[68:83], v[40:41], v[246:247], 0
    v_rcp_f32 v252, v252
    v_rcp_f32 v253, v253
    v_cvt_pk_bf16_f32 v128, v176, v177
    v_cvt_pk_bf16_f32 v129, v178, v179
    v_pk_mul_f32 v[44:45], v[172:173], v[252:253]
    v_pk_mul_f32 v[46:47], v[174:175], v[252:253]
    v_cvt_pk_bf16_f32 v130, v44, v45
    v_cvt_pk_bf16_f32 v131, v46, v47
    v_exp_f32 v44, v52
    v_exp_f32 v45, v53
    v_exp_f32 v46, v54
    v_exp_f32 v47, v55
    v_pk_fma_f32 v[44:45], v[44:45], s[58:59], s[58:59]
    v_pk_add_f32 v[46:47], v[46:47], 1.0 op_sel_hi:[1,0]
    v_mfma_f32_32x32x16_bf16 v[100:115], v[124:127], v[148:151], v[100:115]
    v_rcp_f32 v44, v44
    v_rcp_f32 v45, v45
    v_rcp_f32 v46, v46
    v_rcp_f32 v47, v47
    v_pk_mul_f32 v[44:45], v[44:45], v[52:53]
    v_pk_mul_f32 v[46:47], v[46:47], v[54:55]
    v_cvt_pk_bf16_f32 v116, v44, v45
    v_cvt_pk_bf16_f32 v117, v46, v47
    s_cmp_lt_u32 s12, 1
    v_mfma_f32_32x32x16_bf16 v[100:115], v[128:131], v[152:155], v[100:115]
    ds_read_b64_tr_b16 v[148:149], v28 offset:0
    ds_read_b64_tr_b16 v[150:151], v28 offset:448
    ds_read_b64_tr_b16 v[152:153], v28 offset:896
    ds_read_b64_tr_b16 v[154:155], v28 offset:1344
    s_cbranch_scc1 K_TA1a
    v_exp_f32 v44, v56
    v_exp_f32 v45, v57
    v_exp_f32 v46, v58
    v_exp_f32 v47, v59
    v_pk_fma_f32 v[44:45], v[44:45], s[58:59], s[58:59]
    v_pk_add_f32 v[46:47], v[46:47], 1.0 op_sel_hi:[1,0]
K_TA1a:
    v_mfma_f32_32x32x16_bf16 v[68:83], v[140:143], v[156:159], v[68:83]
    s_cbranch_scc1 K_TA1b
    v_rcp_f32 v44, v44
    v_rcp_f32 v45, v45
    v_rcp_f32 v46, v46
    v_rcp_f32 v47, v47
    v_pk_mul_f32 v[44:45], v[44:45], v[56:57]
    v_pk_mul_f32 v[46:47], v[46:47], v[58:59]
    v_cvt_pk_bf16_f32 v118, v44, v45
    v_cvt_pk_bf16_f32 v119, v46, v47
K_TA1b:
    s_cmp_lt_u32 s12, 2
    v_mfma_f32_32x32x16_bf16 v[68:83], v[144:147], v[160:163], v[68:83]
    s_cbranch_scc1 K_TA2a
    v_exp_f32 v44, v60
    v_exp_f32 v45, v61
    v_exp_f32 v46, v62
    v_exp_f32 v47, v63
    v_pk_fma_f32 v[44:45], v[44:45], s[58:59], s[58:59]
    v_pk_add_f32 v[46:47], v[46:47], 1.0 op_sel_hi:[1,0]
K_TA2a:
    v_mfma_f32_32x32x16_bf16 v[68:83], v[48:51], v[168:171], v[68:83]
    s_cbranch_scc1 K_TA2b
    v_rcp_f32 v44, v44
    v_rcp_f32 v45, v45
    v_rcp_f32 v46, v46
    v_rcp_f32 v47, v47
    v_pk_mul_f32 v[44:45], v[44:45], v[60:61]
    v_pk_mul_f32 v[46:47], v[46:47], v[62:63]
    v_cvt_pk_bf16_f32 v120, v44, v45
    v_cvt_pk_bf16_f32 v121, v46, v47
K_TA2b:
    s_cmp_lt_u32 s12, 3
    s_cbranch_scc1 K_TA3b
    v_exp_f32 v44, v64
    v_exp_f32 v45, v65
    v_exp_f32 v46, v66
    v_exp_f32 v47, v67
    v_pk_fma_f32 v[44:45], v[44:45], s[58:59], s[58:59]
    v_pk_add_f32 v[46:47], v[46:47], 1.0 op_sel_hi:[1,0]
    v_rcp_f32 v44, v44
    v_rcp_f32 v45, v45
    v_rcp_f32 v46, v46
    v_rcp_f32 v47, v47
    v_pk_mul_f32 v[44:45], v[44:45], v[64:65]
    v_pk_mul_f32 v[46:47], v[46:47], v[66:67]
    v_cvt_pk_bf16_f32 v122, v44, v45
    v_cvt_pk_bf16_f32 v123, v46, v47
K_TA3b:
    s_waitcnt lgkmcnt(0)
    v_mfma_f32_32x32x16_bf16 v[84:99], v[116:119], v[148:151], v[84:99]
    s_nop 6
    v_exp_f32 v44, v68
    v_exp_f32 v45, v69
    v_exp_f32 v46, v70
    v_exp_f32 v47, v71
    v_pk_fma_f32 v[44:45], v[44:45], s[58:59], s[58:59]
    v_pk_add_f32 v[46:47], v[46:47], 1.0 op_sel_hi:[1,0]
    v_mfma_f32_32x32x16_bf16 v[84:99], v[120:123], v[152:155], v[84:99]
    v_rcp_f32 v44, v44
    v_rcp_f32 v45, v45
    v_rcp_f32 v46, v46
    v_rcp_f32 v47, v47
    v_pk_mul_f32 v[44:45], v[44:45], v[68:69]
    v_pk_mul_f32 v[46:47], v[46:47], v[70:71]
    v_cvt_pk_bf16_f32 v124, v44, v45
    v_cvt_pk_bf16_f32 v125, v46, v47
    s_cmp_lt_u32 s12, 1
    s_cbranch_scc1 K_TB1b
    v_exp_f32 v44, v72
    v_exp_f32 v45, v73
    v_exp_f32 v46, v74
    v_exp_f32 v47, v75
    v_pk_fma_f32 v[44:45], v[44:45], s[58:59], s[58:59]
    v_pk_add_f32 v[46:47], v[46:47], 1.0 op_sel_hi:[1,0]
    v_rcp_f32 v44, v44
    v_rcp_f32 v45, v45
    v_rcp_f32 v46, v46
    v_rcp_f32 v47, v47
    v_pk_mul_f32 v[44:45], v[44:45], v[72:73]
    v_pk_mul_f32 v[46:47], v[46:47], v[74:75]
    v_cvt_pk_bf16_f32 v126, v44, v45
    v_cvt_pk_bf16_f32 v127, v46, v47
K_TB1b:
    s_nop 1
    v_mfma_f32_32x32x16_bf16 v[100:115], v[124:127], v[148:151], v[100:115]
    v_cvt_pk_bf16_f32 v132, v84, v85
    v_cvt_pk_bf16_f32 v133, v86, v87
    v_cvt_pk_bf16_f32 v134, v88, v89
    v_cvt_pk_bf16_f32 v135, v90, v91
    v_cvt_pk_bf16_f32 v136, v92, v93
    v_cvt_pk_bf16_f32 v137, v94, v95
    v_cvt_pk_bf16_f32 v138, v96, v97
    v_cvt_pk_bf16_f32 v139, v98, v99
    s_cmp_lt_u32 s12, 2
    v_mfma_f32_32x32x16_bf16 v[52:67], v[132:135], v[180:183], 0
    s_cbranch_scc1 K_TB2a
    v_exp_f32 v44, v76
    v_exp_f32 v45, v77
    v_exp_f32 v46, v78
    v_exp_f32 v47, v79
    v_pk_fma_f32 v[44:45], v[44:45], s[58:59], s[58:59]
    v_pk_add_f32 v[46:47], v[46:47], 1.0 op_sel_hi:[1,0]
K_TB2a:
    v_mfma_f32_32x32x16_bf16 v[212:227], v[132:135], v[184:187], 0
    s_cbranch_scc1 K_TB2b
    v_rcp_f32 v44, v44
    v_rcp_f32 v45, v45
    v_rcp_f32 v46, v46
    v_rcp_f32 v47, v47
    v_pk_mul_f32 v[44:45], v[44:45], v[76:77]
    v_pk_mul_f32 v[46:47], v[46:47], v[78:79]
    v_cvt_pk_bf16_f32 v128, v44, v45
    v_cvt_pk_bf16_f32 v129, v46, v47
K_TB2b:
    s_cmp_lt_u32 s12, 3
    v_mfma_f32_32x32x16_bf16 v[52:67], v[136:139], v[188:191], v[52:67]
    s_cbranch_scc1 K_TB3a
    v_exp_f32 v44, v80
    v_exp_f32 v45, v81
    v_exp_f32 v46, v82
    v_exp_f32 v47, v83
    v_pk_fma_f32 v[44:45], v[44:45], s[58:59], s[58:59]
    v_pk_add_f32 v[46:47], v[46:47], 1.0 op_sel_hi:[1,0]
K_TB3a:
    v_mfma_f32_32x32x16_bf16 v[212:227], v[136:139], v[192:195], v[212:227]
    s_cbranch_scc1 K_TB3b
    v_rcp_f32 v44, v44
    v_rcp_f32 v45, v45
    v_rcp_f32 v46, v46
    v_rcp_f32 v47, v47
    v_pk_mul_f32 v[44:45], v[44:45], v[80:81]
    v_pk_mul_f32 v[46:47], v[46:47], v[82:83]
    v_cvt_pk_bf16_f32 v130, v44, v45
    v_cvt_pk_bf16_f32 v131, v46, v47
K_TB3b:
    s_nop 1
    v_mfma_f32_32x32x16_bf16 v[100:115], v[128:131], v[152:155], v[100:115]
K_DRAINED:
    s_cmp_lg_u32 s86, 0
    s_cbranch_scc1 K_NEXT
K_EPI:
    ds_read2_b64 v[68:71], v6 offset0:0 offset1:2
    ds_read2_b64 v[72:75], v6 offset0:8 offset1:10
    ds_read2_b64 v[76:79], v6 offset0:4 offset1:6
    ds_read2_b64 v[80:83], v6 offset0:12 offset1:14
    s_mov_b32 s92, 1280000
    s_movk_i32 s93, 0x7777
    s_cmp_eq_u32 s91, 5
    s_cselect_b32 s93, 0x77777, s93
    s_movk_i32 s94, 0x207
    s_nop 0
    v_cvt_pk_bf16_f32 v140, v100, v101
    v_cvt_pk_bf16_f32 v141, v102, v103
    v_cvt_pk_bf16_f32 v142, v104, v105
    v_cvt_pk_bf16_f32 v143, v106, v107
    v_cvt_pk_bf16_f32 v144, v108, v109
    v_cvt_pk_bf16_f32 v145, v110, v111
    v_mfma_f32_32x32x16_bf16 v[52:67], v[140:143], v[196:199], v[52:67]
    v_cvt_pk_bf16_f32 v146, v112, v113
    v_cvt_pk_bf16_f32 v147, v114, v115
    v_mfma_f32_32x32x16_bf16 v[212:227], v[140:143], v[200:203], v[212:227]
    s_nop 0
    v_mfma_f32_32x32x16_bf16 v[52:67], v[144:147], v[204:207], v[52:67]
    v_mfma_f32_32x32x16_bf16 v[212:227], v[144:147], v[208:211], v[212:227]
    s_waitcnt vmcnt(0) lgkmcnt(0)
    v_mfma_f32_32x32x16_bf16 v[84:99], v[68:71], v[132:135], 0
    s_nop 8
    v_fma_f32 v124, v52, s60, v228
    v_fma_f32 v125, v56, s60, v229
    v_fma_f32 v126, v60, s60, v230
    v_mul_f32 v116, s90, v124
    v_mul_f32 v117, s90, v125
    v_mul_f32 v118, s90, v126
    v_mfma_f32_32x32x16_bf16 v[84:99], v[72:75], v[136:139], v[84:99]
    v_fma_f32 v127, v212, s60, v231
    v_fma_f32 v128, v216, s60, v232
    v_fma_f32 v129, v220, s60, v233
    v_mul_f32 v119, s90, v127
    v_mul_f32 v120, s90, v128
    v_mul_f32 v121, s90, v129
    v_mfma_f32_32x32x16_bf16 v[84:99], v[76:79], v[140:143], v[84:99]
    v_exp_f32 v116, v116
    v_exp_f32 v117, v117
    v_exp_f32 v118, v118
    v_mfma_f32_32x32x16_bf16 v[84:99], v[80:83], v[144:147], v[84:99]
    v_exp_f32 v119, v119
    v_exp_f32 v120, v120
    v_exp_f32 v121, v121
    v_add_f32 v116, 1.0, v116
    v_add_f32 v117, 1.0, v117
    v_add_f32 v118, 1.0, v118
    v_add_f32 v119, 1.0, v119
    v_add_f32 v120, 1.0, v120
    v_add_f32 v121, 1.0, v121
    v_rcp_f32 v116, v116
    v_rcp_f32 v117, v117
    v_rcp_f32 v118, v118
    v_rcp_f32 v119, v119
    v_rcp_f32 v120, v120
    v_rcp_f32 v121, v121
    v_fmac_f32 v234, v124, v116
    v_fmac_f32 v235, v125, v117
    v_fmac_f32 v236, v126, v118
    v_fmac_f32 v237, v127, v119
    v_fmac_f32 v238, v128, v120
    v_fmac_f32 v239, v129, v121
    v_cvt_pk_bf16_f32 v234, v234, v237
    v_cvt_pk_bf16_f32 v235, v235, v238
    v_cvt_pk_bf16_f32 v236, v236, v239
    v_cmp_class_f32 vcc, v84, s94
    v_fmac_f32 v242, s60, v84
    v_cvt_pk_bf16_f32 v242, v242, v242
    s_cbranch_vccnz K_REDO
K_STORE:
    buffer_store_short v234, v248, s[44:47], 0 offen offset:0
    buffer_store_short_d16_hi v234, v248, s[44:47], 0 offen offset:64
    buffer_store_short v235, v248, s[44:47], 0 offen offset:256
    buffer_store_short_d16_hi v235, v248, s[44:47], 0 offen offset:320
    s_mov_b32 exec_hi, 0
    s_cbranch_scc0 K_FOUR
    buffer_store_short v236, v248, s[44:47], 0 offen offset:512
    buffer_store_short_d16_hi v236, v248, s[44:47], 0 offen offset:576
K_FOUR:
    s_lshl_b32 exec_lo, s93, 1
    buffer_store_short v242, v249, s[44:47], s92 offen
    s_or_b32 s92, s2, s3
    s_cbranch_scc1 K_NOEPO
    v_mov_b32 v44, 5308416
    v_mov_b32 v46, s26
    v_mov_b32 v47, s27
    global_store_dwordx2 v44, v[46:47], s[24:25]
K_NOEPO:
K_END:
    s_endpgm
K_STAGE:
    s_setprio 1
    s_mov_b32 s11, 1
    s_cmp_eq_u32 s87, 2
    s_cbranch_scc1 K_LOOP
    s_setprio 2
    s_mov_b32 s11, 2
    s_branch K_LOOP
K_OFFRE:
    s_mov_b64 exec, vcc
    global_load_dwordx4 v[100:103], v144, s[24:25] sc1
    global_load_dwordx4 v[104:107], v145, s[24:25] sc1
    s_mov_b64 exec, -1
    s_add_u32 s20, s20, 1
    s_cmp_lt_u32 s20, 0x200000
    s_waitcnt vmcnt(0)
    s_cbranch_scc1 K_OFFCHK
    s_endpgm
K_SHORT:
    s_cmp_lg_u32 s87, 0
    s_cbranch_scc1 K_SHORT1
    buffer_load_short_d16_hi v234, v248, s[40:43], 0 offen offset:0
    buffer_load_short_d16_hi v237, v248, s[40:43], 0 offen offset:64
    buffer_load_short_d16_hi v235, v248, s[40:43], 0 offen offset:256
    buffer_load_short_d16_hi v238, v248, s[40:43], 0 offen offset:320
    buffer_load_short_d16_hi v236, v248, s[40:43], 0 offen offset:512
    buffer_load_short_d16_hi v239, v248, s[40:43], 0 offen offset:576
    buffer_load_short_d16_hi v242, v249, s[36:39], 0 offen
    s_cmp_lg_u32 s86, 0
    s_cbranch_scc1 K_NEXT
K_EPI0:
    v_cvt_pk_bf16_f32 v132, v84, v85
    v_cvt_pk_bf16_f32 v133, v86, v87
    v_cvt_pk_bf16_f32 v134, v88, v89
    v_cvt_pk_bf16_f32 v135, v90, v91
    v_cvt_pk_bf16_f32 v136, v92, v93
    v_cvt_pk_bf16_f32 v137, v94, v95
    v_cvt_pk_bf16_f32 v138, v96, v97
    v_cvt_pk_bf16_f32 v139, v98, v99
    s_nop 0
    v_mfma_f32_32x32x16_bf16 v[52:67], v[132:135], v[180:183], 0
    v_mfma_f32_32x32x16_bf16 v[212:227], v[132:135], v[184:187], 0
    v_mfma_f32_32x32x16_bf16 v[52:67], v[136:139], v[188:191], v[52:67]
    v_mfma_f32_32x32x16_bf16 v[212:227], v[136:139], v[192:195], v[212:227]
    s_branch K_EPI
K_SHORT1:
    s_cmp_gt_u32 s87, 1
    s_cselect_b32 s12, 3, s12
    s_branch K_TAIL
K_REDO:
    s_cmp_lg_u32 s86, 0
    s_cbranch_scc1 K_REDONE
    s_mov_b32 s86, 14
    v_pk_mov_b32 v[84:85], 0, 0
    v_pk_mov_b32 v[86:87], 0, 0
    v_pk_mov_b32 v[88:89], 0, 0
    v_pk_mov_b32 v[90:91], 0, 0
    v_pk_mov_b32 v[92:93], 0, 0
    v_pk_mov_b32 v[94:95], 0, 0
    v_pk_mov_b32 v[96:97], 0, 0
    v_pk_mov_b32 v[98:99], 0, 0
    v_pk_mov_b32 v[100:101], 0, 0
    v_pk_mov_b32 v[102:103], 0, 0
    v_pk_mov_b32 v[104:105], 0, 0
    v_pk_mov_b32 v[106:107], 0, 0
    v_pk_mov_b32 v[108:109], 0, 0
    v_pk_mov_b32 v[110:111], 0, 0
    v_pk_mov_b32 v[112:113], 0, 0
    v_pk_mov_b32 v[114:115], 0, 0
    v_pk_mov_b32 v[116:117], 0, 0
    v_pk_mov_b32 v[118:119], 0, 0
    v_pk_mov_b32 v[120:121], 0, 0
    v_pk_mov_b32 v[122:123], 0, 0
    v_pk_mov_b32 v[234:235], 0, 0
    v_pk_mov_b32 v[236:237], 0, 0
    v_pk_mov_b32 v[238:239], 0, 0
    v_mov_b32 v242, 0
    v_mov_b32 v26, 1.0
    v_mov_b32 v27, 1.0
    s_mov_b32 s58, 1.0
    s_mov_b32 s59, 1.0
    s_branch K_PROCESS
K_REDONE:
    s_cmp_eq_u32 s91, 5
    s_branch K_STORE
K_NEXT:
    s_waitcnt vmcnt(0) lgkmcnt(0)
    s_or_b32 s86, s86, 2
    s_cmp_lt_u32 s87, 2
    s_cbranch_scc1 K_LISTDONE
    s_sub_u32 s22, s22, 256
    v_lshl_add_u64 v[4:5], v[4:5], 0, s[56:57]
    s_branch K_PP
K_LISTDONE:
    s_bitcmp1_b32 s86, 0
    s_cbranch_scc1 K_SLOW_NEXT
    s_branch K_EPI0
K_LONG:
    global_load_dword v62, v152, s[24:25] offset:80 sc1
    global_load_dword v63, v153, s[24:25] offset:80 sc1
    v_cmp_lt_i32 vcc, 0x60, v136
    s_mov_b64 s[16:17], vcc
    v_cmp_lt_i32 vcc, 0x80, v136
    s_cbranch_vccz K_LONG_BACK
    v_mov_b32 v137, 1
    ds_write_b32 v2, v137 offset:32
    s_branch K_LONG_BACK
K_R2:
    v_subrev_u32 v66, 64, v66
    v_subrev_u32 v67, 64, v67
    v_cmp_lt_i32 s[64:65], 16, v66
    v_cmp_lt_i32 s[66:67], 16, v67
    v_lshrrev_b32 v68, 13, v62
    v_bitop3_b32 v68, v68, 14, v147 bitop3:0xea
    v_lshrrev_b32 v69, 13, v63
    v_bitop3_b32 v69, v69, 14, v147 bitop3:0xea
    ds_read_u16 v68, v68 offset:0
    ds_read_u16 v69, v69 offset:256
    v_lshrrev_b32 v85, 20, v62
    v_add_u32 v85, v140, v85
    v_and_b32 v84, v65, v62
    v_lshrrev_b32 v87, 20, v63
    v_add_u32 v87, v141, v87
    v_and_b32 v86, v65, v63
    s_waitcnt lgkmcnt(0)
    v_add_u32 v68, v68, v133
    v_add_u32 v69, v69, v133
    s_mov_b64 exec, s[64:65]
    ds_write_b64 v68, v[84:85] offset:416
    s_mov_b64 exec, s[66:67]
    ds_write_b64 v69, v[86:87] offset:416
    s_mov_b64 exec, -1
    s_cmp_eq_u64 s[16:17], 0
    s_cbranch_scc1 K_PAIRING
    global_load_dword v52, v152, s[24:25] offset:96 sc1
    global_load_dword v53, v153, s[24:25] offset:96 sc1
    global_load_dword v54, v152, s[24:25] offset:112 sc1
    global_load_dword v55, v153, s[24:25] offset:112 sc1
    v_cmp_lt_i32 s[64:65], 32, v66
    v_cmp_lt_i32 s[66:67], 32, v67
    v_cmp_lt_i32 s[68:69], 48, v66
    v_cmp_lt_i32 s[70:71], 48, v67
    s_waitcnt vmcnt(0)
    v_lshrrev_b32 v68, 13, v52
    v_bitop3_b32 v68, v68, 14, v147 bitop3:0xea
    v_lshrrev_b32 v69, 13, v53
    v_bitop3_b32 v69, v69, 14, v147 bitop3:0xea
    v_lshrrev_b32 v70, 13, v54
    v_bitop3_b32 v70, v70, 14, v147 bitop3:0xea
    v_lshrrev_b32 v71, 13, v55
    v_bitop3_b32 v71, v71, 14, v64 bitop3:0xea
    ds_read_u16 v68, v68 offset:0
    ds_read_u16 v69, v69 offset:256
    ds_read_u16 v70, v70 offset:0
    ds_read_u16 v71, v71 offset:256
    v_lshrrev_b32 v85, 20, v52
    v_add_u32 v85, v140, v85
    v_and_b32 v84, v65, v52
    v_lshrrev_b32 v87, 20, v53
    v_add_u32 v87, v141, v87
    v_and_b32 v86, v65, v53
    v_lshrrev_b32 v89, 20, v54
    v_add_u32 v89, v140, v89
    v_and_b32 v88, v65, v54
    v_lshrrev_b32 v91, 20, v55
    v_add_u32 v91, v141, v91
    v_and_b32 v90, v65, v55
    s_waitcnt lgkmcnt(0)
    v_add_u32 v68, v68, v133
    v_add_u32 v69, v69, v133
    v_add_u32 v70, v70, v133
    v_add_u32 v71, v71, v133
    s_mov_b64 exec, s[64:65]
    ds_write_b64 v68, v[84:85] offset:448
    s_mov_b64 exec, s[66:67]
    ds_write_b64 v69, v[86:87] offset:448
    s_mov_b64 exec, s[68:69]
    ds_write_b64 v70, v[88:89] offset:480
    s_mov_b64 exec, s[70:71]
    ds_write_b64 v71, v[90:91] offset:480
    s_mov_b64 exec, -1
    s_branch K_PAIRING
K_SLOW_INIT:
    s_waitcnt lgkmcnt(0)
    v_mov_b32 v26, 1.0
    v_mov_b32 v27, 1.0
    s_mov_b32 s58, 1.0
    s_mov_b32 s59, 1.0
    s_mov_b32 s48, 0
    s_branch K_SLOW_CHUNK
K_SLOW_NEXT:
    s_add_u32 s49, s49, 1536
    s_cmp_lt_u32 s49, s50
    s_cbranch_scc1 K_SLOW_ROUND
    s_add_u32 s48, s48, 1
    s_cmp_ge_u32 s48, 256
    s_cbranch_scc1 K_EPI0
K_SLOW_CHUNK:
    s_lshl_b32 s92, s48, 12
    s_add_u32 s92, s92, 3145728
    v_min_u32 v136, 1, v1
    v_add_u32 v136, s84, v136
    v_min_u32 v136, 0xff, v136
    v_lshl_add_u32 v136, v136, 4, s92
    s_and_b32 s92, s27, 0xffff
    v_mov_b32 v139, s92
K_SLOW_POLL:
    global_load_dwordx4 v[68:71], v136, s[24:25] sc1
    s_add_u32 s20, s20, 1
    s_cmp_gt_u32 s20, 0x200000
    s_cbranch_scc1 K_END
    s_waitcnt vmcnt(0)
    v_cmp_ne_u32 vcc, s26, v71
    v_cmp_ne_u32_sdwa s[92:93], v139, v68 src0_sel:DWORD src1_sel:WORD_1
    v_readlane_b32 s49, v68, 0
    v_readlane_b32 s50, v68, 1
    s_or_b64 vcc, vcc, s[92:93]
    s_cbranch_scc1 K_SLOW_POLL
    s_and_b32 s49, s49, 0xffff
    s_and_b32 s50, s50, 0xffff
    s_cmp_eq_u32 s84, 0xff
    s_cselect_b32 s50, 10000, s50
K_SLOW_ROUND:
    s_waitcnt lgkmcnt(0)
    s_barrier
    s_mul_i32 s92, s3, 4112
    v_lshl_add_u32 v72, v1, 4, s92
    v_mov_b32 v68, 0xa2710
    v_mov_b32 v69, v68
    v_pk_mov_b32 v[70:71], v[68:69], v[68:69]
    v_lshlrev_b32 v73, 2, v1
    ds_write_b128 v72, v[68:71] offset:512
    ds_write_b128 v72, v[68:71] offset:1536
    ds_write_b128 v72, v[68:71] offset:2560
    ds_write_b128 v72, v[68:71] offset:3584
    ds_write_b32 v73, v2 offset:256
    s_mul_i32 s10, s3, 2056
    s_add_u32 s10, s10, 512
    s_lshl_b32 s93, s3, 1
    v_mov_b32 v139, s93
    v_mov_b32 v138, s10
    ds_write_b16 v139, v138 offset:0
    s_mul_i32 s94, s48, 2500
    s_mul_i32 s95, s48, 10240
    v_lshl_add_u32 v136, v0, 2, s49
    s_add_u32 s96, s49, 1536
    s_min_u32 s96, s96, s50
    v_cmp_gt_u32 vcc, s96, v136
    v_min_u32 v136, 10236, v136
    v_add_u32 v136, s95, v136
    global_load_dword v52, v136, s[24:25] sc1
    s_waitcnt vmcnt(0) lgkmcnt(0)
    s_barrier
    v_lshrrev_b32 v136, 13, v52
    v_and_b32 v136, 12, v136
    v_bfe_u32 v137, v52, 14, 1
    v_lshlrev_b32 v137, 4, v137
    v_lshlrev_b32 v138, v137, 4
    v_lshrrev_b32 v69, 20, v52
    v_add_u32 v69, s94, v69
    v_and_b32 v68, s19, v52
    s_mov_b64 exec, vcc
    ds_add_rtn_u32 v136, v136, v138 offset:0
    s_waitcnt lgkmcnt(0)
    v_bfe_u32 v136, v136, v137, 16
    v_lshlrev_b32 v136, 1, v136
    ds_write_b64 v136, v[68:69] offset:256
    s_mov_b64 exec, -1
    s_waitcnt lgkmcnt(0)
    s_barrier
    ds_read_u16 v137, v139 offset:0
    s_waitcnt lgkmcnt(0)
    v_readfirstlane_b32 s21, v137
    s_sub_u32 s21, s21, s10
    s_lshl_b32 s21, s21, 1
    s_mov_b32 s10, 0
    s_branch K_PROCESS
.p2align 7
.type K_TAB,@object
K_TAB:
.long 0x0, 0x0, 0x0, 0xbf800000
.long 0x8, 0x0, 0x0, 0xbf800000
.long 0x10, 0x0, 0x0, 0xbf800000
.long 0x18, 0x0, 0x0, 0xbf800000
.long 0x20, 0x0, 0x0, 0xbf800000
.long 0x28, 0x0, 0x0, 0xbf800000
.long 0x30, 0x0, 0x0, 0xbf800000
.long 0x38, 0x0, 0x0, 0xbf800000
.long 0x40, 0x8, 0x0, 0xbf800000
.long 0x48, 0x8, 0x0, 0xbf800000
.long 0x50, 0x8, 0x0, 0xbf800000
.long 0x58, 0x8, 0x0, 0xbf800000
.long 0x60, 0x8, 0x0, 0xbf800000
.long 0x68, 0x8, 0x0, 0xbf800000
.long 0x70, 0x8, 0x0, 0xbf800000
.long 0x78, 0x8, 0x0, 0xbf800000
.long 0x80, 0x10, 0x0, 0xbf800000
.long 0x88, 0x10, 0x0, 0xbf800000
.long 0x90, 0x10, 0x0, 0xbf800000
.long 0x98, 0x10, 0x0, 0xbf800000
.long 0xa0, 0x10, 0x0, 0xbf800000
.long 0xa8, 0x10, 0x0, 0xbf800000
.long 0xb0, 0x10, 0x0, 0xbf800000
.long 0xb8, 0x10, 0x0, 0xbf800000
.long 0xc0, 0x18, 0x0, 0xbf800000
.long 0xc8, 0x18, 0x0, 0xbf800000
.long 0xd0, 0x18, 0x0, 0xbf800000
.long 0xd8, 0x18, 0x0, 0xbf800000
.long 0xe0, 0x18, 0x0, 0xbf800000
.long 0xe8, 0x18, 0x0, 0xbf800000
.long 0xf0, 0x18, 0x0, 0xbf800000
.long 0xf8, 0x18, 0x0, 0xbf800000
.long 0x0, 0x20, 0xbf800000, 0xbf800000
.long 0x8, 0x20, 0xbf800000, 0xbf800000
.long 0x10, 0x20, 0xbf800000, 0xbf800000
.long 0x18, 0x20, 0xbf800000, 0xbf800000
.long 0x20, 0x20, 0xbf800000, 0xbf800000
.long 0x28, 0x20, 0xbf800000, 0xbf800000
.long 0x30, 0x20, 0xbf800000, 0xbf800000
.long 0x38, 0x20, 0xbf800000, 0xbf800000
.long 0x40, 0x28, 0xbf800000, 0xbf800000
.long 0x48, 0x28, 0xbf800000, 0xbf800000
.long 0x50, 0x28, 0xbf800000, 0xbf800000
.long 0x58, 0x28, 0xbf800000, 0xbf800000
.long 0x60, 0x28, 0xbf800000, 0xbf800000
.long 0x68, 0x28, 0xbf800000, 0xbf800000
.long 0x70, 0x28, 0xbf800000, 0xbf800000
.long 0x78, 0x28, 0xbf800000, 0xbf800000
.long 0x80, 0x30, 0xbf800000, 0xbf800000
.long 0x88, 0x30, 0xbf800000, 0xbf800000
.long 0x90, 0x30, 0xbf800000, 0xbf800000
.long 0x98, 0x30, 0xbf800000, 0xbf800000
.long 0xa0, 0x30, 0xbf800000, 0xbf800000
.long 0xa8, 0x30, 0xbf800000, 0xbf800000
.long 0xb0, 0x30, 0xbf800000, 0xbf800000
.long 0xb8, 0x30, 0xbf800000, 0xbf800000
.long 0xc0, 0x38, 0xbf800000, 0xbf800000
.long 0xc8, 0x38, 0xbf800000, 0xbf800000
.long 0xd0, 0x38, 0xbf800000, 0xbf800000
.long 0xd8, 0x38, 0xbf800000, 0xbf800000
.long 0xe0, 0x38, 0xbf800000, 0xbf800000
.long 0xe8, 0x38, 0xbf800000, 0xbf800000
.long 0xf0, 0x38, 0xbf800000, 0xbf800000
.long 0xf8, 0x38, 0xbf800000, 0xbf800000
.long 0x0, 0x20, 0x40, 0x60
.long 0x80, 0xa0, 0xc0, 0xe0
.long 0x110, 0x130, 0x150, 0x170
.long 0x190, 0x1b0, 0x1d0, 0x1f0
.long 0x220, 0x200, 0x260, 0x240
.long 0x2a0, 0x280, 0x2e0, 0x2c0
.long 0x330, 0x310, 0x370, 0x350
.long 0x3b0, 0x390, 0x3f0, 0x3d0
.long 0x440, 0x460, 0x400, 0x420
.long 0x4c0, 0x4e0, 0x480, 0x4a0
.long 0x550, 0x570, 0x510, 0x530
.long 0x5d0, 0x5f0, 0x590, 0x5b0
.long 0x660, 0x640, 0x620, 0x600
.long 0x6e0, 0x6c0, 0x6a0, 0x680
.long 0x770, 0x750, 0x730, 0x710
.long 0x7f0, 0x7d0, 0x7b0, 0x790
.long 0x800, 0x820, 0x840, 0x860
.long 0x880, 0x8a0, 0x8c0, 0x8e0
.long 0x910, 0x930, 0x950, 0x970
.long 0x990, 0x9b0, 0x9d0, 0x9f0
.long 0xa20, 0xa00, 0xa60, 0xa40
.long 0xaa0, 0xa80, 0xae0, 0xac0
.long 0xb30, 0xb10, 0xb70, 0xb50
.long 0xbb0, 0xb90, 0xbf0, 0xbd0
.long 0xc40, 0xc60, 0xc00, 0xc20
.long 0xcc0, 0xce0, 0xc80, 0xca0
.long 0xd50, 0xd70, 0xd10, 0xd30
.long 0xdd0, 0xdf0, 0xd90, 0xdb0
.long 0xe60, 0xe40, 0xe20, 0xe00
.long 0xee0, 0xec0, 0xea0, 0xe80
.long 0xf70, 0xf50, 0xf30, 0xf10
.long 0xff0, 0xfd0, 0xfb0, 0xf90
.long 0x10, 0x30, 0x50, 0x70
.long 0x90, 0xb0, 0xd0, 0xf0
.long 0x100, 0x120, 0x140, 0x160
.long 0x180, 0x1a0, 0x1c0, 0x1e0
.long 0x230, 0x210, 0x270, 0x250
.long 0x2b0, 0x290, 0x2f0, 0x2d0
.long 0x320, 0x300, 0x360, 0x340
.long 0x3a0, 0x380, 0x3e0, 0x3c0
.long 0x450, 0x470, 0x410, 0x430
.long 0x4d0, 0x4f0, 0x490, 0x4b0
.long 0x540, 0x560, 0x500, 0x520
.long 0x5c0, 0x5e0, 0x580, 0x5a0
.long 0x670, 0x650, 0x630, 0x610
.long 0x6f0, 0x6d0, 0x6b0, 0x690
.long 0x760, 0x740, 0x720, 0x700
.long 0x7e0, 0x7c0, 0x7a0, 0x780
.long 0x810, 0x830, 0x850, 0x870
.long 0x890, 0x8b0, 0x8d0, 0x8f0
.long 0x900, 0x920, 0x940, 0x960
.long 0x980, 0x9a0, 0x9c0, 0x9e0
.long 0xa30, 0xa10, 0xa70, 0xa50
.long 0xab0, 0xa90, 0xaf0, 0xad0
.long 0xb20, 0xb00, 0xb60, 0xb40
.long 0xba0, 0xb80, 0xbe0, 0xbc0
.long 0xc50, 0xc70, 0xc10, 0xc30
.long 0xcd0, 0xcf0, 0xc90, 0xcb0
.long 0xd40, 0xd60, 0xd00, 0xd20
.long 0xdc0, 0xde0, 0xd80, 0xda0
.long 0xe70, 0xe50, 0xe30, 0xe10
.long 0xef0, 0xed0, 0xeb0, 0xe90
.long 0xf60, 0xf40, 0xf20, 0xf00
.long 0xfe0, 0xfc0, 0xfa0, 0xf80
.long 0x0, 0xc00, 0x0, 0x840
.long 0x0, 0xc10, 0x0, 0x850
.long 0x0, 0xc20, 0x0, 0x860
.long 0x0, 0xc30, 0x0, 0x870
.long 0x0, 0xc40, 0x0, 0x800
.long 0x0, 0xc50, 0x0, 0x810
.long 0x0, 0xc60, 0x0, 0x820
.long 0x0, 0xc70, 0x0, 0x830
.long 0x0, 0xc00, 0x0, 0x840
.long 0x0, 0xc10, 0x0, 0x850
.long 0x0, 0xc20, 0x0, 0x860
.long 0x0, 0xc30, 0x0, 0x870
.long 0x0, 0xc40, 0x0, 0x800
.long 0x0, 0xc50, 0x0, 0x810
.long 0x0, 0xc60, 0x0, 0x820
.long 0x0, 0xc70, 0x0, 0x830
.long 0x0, 0xc10, 0x0, 0x850
.long 0x0, 0xc00, 0x0, 0x840
.long 0x0, 0xc30, 0x0, 0x870
.long 0x0, 0xc20, 0x0, 0x860
.long 0x0, 0xc50, 0x0, 0x810
.long 0x0, 0xc40, 0x0, 0x800
.long 0x0, 0xc70, 0x0, 0x830
.long 0x0, 0xc60, 0x0, 0x820
.long 0x0, 0xc10, 0x0, 0x850
.long 0x0, 0xc00, 0x0, 0x840
.long 0x0, 0xc30, 0x0, 0x870
.long 0x0, 0xc20, 0x0, 0x860
.long 0x0, 0xc50, 0x0, 0x810
.long 0x0, 0xc40, 0x0, 0x800
.long 0x0, 0xc70, 0x0, 0x830
.long 0x0, 0xc60, 0x0, 0x820
.long 0x0, 0xc20, 0x0, 0x860
.long 0x0, 0xc30, 0x0, 0x870
.long 0x0, 0xc00, 0x0, 0x840
.long 0x0, 0xc10, 0x0, 0x850
.long 0x0, 0xc60, 0x0, 0x820
.long 0x0, 0xc70, 0x0, 0x830
.long 0x0, 0xc40, 0x0, 0x800
.long 0x0, 0xc50, 0x0, 0x810
.long 0x0, 0xc20, 0x0, 0x860
.long 0x0, 0xc30, 0x0, 0x870
.long 0x0, 0xc00, 0x0, 0x840
.long 0x0, 0xc10, 0x0, 0x850
.long 0x0, 0xc60, 0x0, 0x820
.long 0x0, 0xc70, 0x0, 0x830
.long 0x0, 0xc40, 0x0, 0x800
.long 0x0, 0xc50, 0x0, 0x810
.long 0x0, 0xc30, 0x0, 0x870
.long 0x0, 0xc20, 0x0, 0x860
.long 0x0, 0xc10, 0x0, 0x850
.long 0x0, 0xc00, 0x0, 0x840
.long 0x0, 0xc70, 0x0, 0x830
.long 0x0, 0xc60, 0x0, 0x820
.long 0x0, 0xc50, 0x0, 0x810
.long 0x0, 0xc40, 0x0, 0x800
.long 0x0, 0xc30, 0x0, 0x870
.long 0x0, 0xc20, 0x0, 0x860
.long 0x0, 0xc10, 0x0, 0x850
.long 0x0, 0xc00, 0x0, 0x840
.long 0x0, 0xc70, 0x0, 0x830
.long 0x0, 0xc60, 0x0, 0x820
.long 0x0, 0xc50, 0x0, 0x810
.long 0x0, 0xc40, 0x0, 0x800
.long 0x0, 0x400, 0x0, 0x40
.long 0x0, 0x410, 0x0, 0x50
.long 0x0, 0x420, 0x0, 0x60
.long 0x0, 0x430, 0x0, 0x70
.long 0x0, 0x440, 0x0, 0x0
.long 0x0, 0x450, 0x0, 0x10
.long 0x0, 0x460, 0x0, 0x20
.long 0x0, 0x470, 0x0, 0x30
.long 0x0, 0x400, 0x0, 0x40
.long 0x0, 0x410, 0x0, 0x50
.long 0x0, 0x420, 0x0, 0x60
.long 0x0, 0x430, 0x0, 0x70
.long 0x0, 0x440, 0x0, 0x0
.long 0x0, 0x450, 0x0, 0x10
.long 0x0, 0x460, 0x0, 0x20
.long 0x0, 0x470, 0x0, 0x30
.long 0x0, 0x410, 0x0, 0x50
.long 0x0, 0x400, 0x0, 0x40
.long 0x0, 0x430, 0x0, 0x70
.long 0x0, 0x420, 0x0, 0x60
.long 0x0, 0x450, 0x0, 0x10
.long 0x0, 0x440, 0x0, 0x0
.long 0x0, 0x470, 0x0, 0x30
.long 0x0, 0x460, 0x0, 0x20
.long 0x0, 0x410, 0x0, 0x50
.long 0x0, 0x400, 0x0, 0x40
.long 0x0, 0x430, 0x0, 0x70
.long 0x0, 0x420, 0x0, 0x60
.long 0x0, 0x450, 0x0, 0x10
.long 0x0, 0x440, 0x0, 0x0
.long 0x0, 0x470, 0x0, 0x30
.long 0x0, 0x460, 0x0, 0x20
.long 0x0, 0x420, 0x0, 0x60
.long 0x0, 0x430, 0x0, 0x70
.long 0x0, 0x400, 0x0, 0x40
.long 0x0, 0x410, 0x0, 0x50
.long 0x0, 0x460, 0x0, 0x20
.long 0x0, 0x470, 0x0, 0x30
.long 0x0, 0x440, 0x0, 0x0
.long 0x0, 0x450, 0x0, 0x10
.long 0x0, 0x420, 0x0, 0x60
.long 0x0, 0x430, 0x0, 0x70
.long 0x0, 0x400, 0x0, 0x40
.long 0x0, 0x410, 0x0, 0x50
.long 0x0, 0x460, 0x0, 0x20
.long 0x0, 0x470, 0x0, 0x30
.long 0x0, 0x440, 0x0, 0x0
.long 0x0, 0x450, 0x0, 0x10
.long 0x0, 0x430, 0x0, 0x70
.long 0x0, 0x420, 0x0, 0x60
.long 0x0, 0x410, 0x0, 0x50
.long 0x0, 0x400, 0x0, 0x40
.long 0x0, 0x470, 0x0, 0x30
.long 0x0, 0x460, 0x0, 0x20
.long 0x0, 0x450, 0x0, 0x10
.long 0x0, 0x440, 0x0, 0x0
.long 0x0, 0x430, 0x0, 0x70
.long 0x0, 0x420, 0x0, 0x60
.long 0x0, 0x410, 0x0, 0x50
.long 0x0, 0x400, 0x0, 0x40
.long 0x0, 0x470, 0x0, 0x30
.long 0x0, 0x460, 0x0, 0x20
.long 0x0, 0x450, 0x0, 0x10
.long 0x0, 0x440, 0x0, 0x0
.long 0x0, 0x0, 0x27800000, 0x27800000
.long 0x0, 0x0, 0x27800000, 0x27800000
.long 0x0, 0x0, 0x3f800000, 0x3f800000
.long 0x0, 0x0, 0x3f800000, 0x3f800000
.long 0x0, 0x0, 0x27800000, 0x27800000
.long 0x0, 0x0, 0x27800000, 0x27800000
.long 0x0, 0x0, 0x3f800000, 0x3f800000
.long 0x0, 0x0, 0x3f800000, 0x3f800000
.long 0x0, 0x0, 0x27800000, 0x27800000
.long 0x0, 0x0, 0x27800000, 0x27800000
.long 0x0, 0x0, 0x3f800000, 0x3f800000
.long 0x0, 0x0, 0x3f800000, 0x3f800000
.long 0x0, 0x0, 0x27800000, 0x27800000
.long 0x0, 0x0, 0x27800000, 0x27800000
.long 0x0, 0x0, 0x3f800000, 0x3f800000
.long 0x0, 0x0, 0x3f800000, 0x3f800000
.long 0x0, 0x0, 0x27800000, 0x27800000
.long 0x0, 0x0, 0x27800000, 0x27800000
.long 0x0, 0x0, 0x3f800000, 0x3f800000
.long 0x0, 0x0, 0x3f800000, 0x3f800000
.long 0x0, 0x0, 0x27800000, 0x27800000
.long 0x0, 0x0, 0x27800000, 0x27800000
.long 0x0, 0x0, 0x3f800000, 0x3f800000
.long 0x0, 0x0, 0x3f800000, 0x3f800000
.long 0x0, 0x0, 0x27800000, 0x27800000
.long 0x0, 0x0, 0x27800000, 0x27800000
.long 0x0, 0x0, 0x3f800000, 0x3f800000
.long 0x0, 0x0, 0x3f800000, 0x3f800000
.long 0x0, 0x0, 0x27800000, 0x27800000
.long 0x0, 0x0, 0x27800000, 0x27800000
.long 0x0, 0x0, 0x3f800000, 0x3f800000
.long 0x0, 0x0, 0x3f800000, 0x3f800000
.long 0x0, 0x1, 0x27800000, 0x27800000
.long 0x0, 0x1, 0x27800000, 0x27800000
.long 0x0, 0x1, 0x3f800000, 0x3f800000
.long 0x0, 0x1, 0x3f800000, 0x3f800000
.long 0x0, 0x1, 0x27800000, 0x27800000
.long 0x0, 0x1, 0x27800000, 0x27800000
.long 0x0, 0x1, 0x3f800000, 0x3f800000
.long 0x0, 0x1, 0x3f800000, 0x3f800000
.long 0x0, 0x1, 0x27800000, 0x27800000
.long 0x0, 0x1, 0x27800000, 0x27800000
.long 0x0, 0x1, 0x3f800000, 0x3f800000
.long 0x0, 0x1, 0x3f800000, 0x3f800000
.long 0x0, 0x1, 0x27800000, 0x27800000
.long 0x0, 0x1, 0x27800000, 0x27800000
.long 0x0, 0x1, 0x3f800000, 0x3f800000
.long 0x0, 0x1, 0x3f800000, 0x3f800000
.long 0x0, 0x1, 0x27800000, 0x27800000
.long 0x0, 0x1, 0x27800000, 0x27800000
.long 0x0, 0x1, 0x3f800000, 0x3f800000
.long 0x0, 0x1, 0x3f800000, 0x3f800000
.long 0x0, 0x1, 0x27800000, 0x27800000
.long 0x0, 0x1, 0x27800000, 0x27800000
.long 0x0, 0x1, 0x3f800000, 0x3f800000
.long 0x0, 0x1, 0x3f800000, 0x3f800000
.long 0x0, 0x1, 0x27800000, 0x27800000
.long 0x0, 0x1, 0x27800000, 0x27800000
.long 0x0, 0x1, 0x3f800000, 0x3f800000
.long 0x0, 0x1, 0x3f800000, 0x3f800000
.long 0x0, 0x1, 0x27800000, 0x27800000
.long 0x0, 0x1, 0x27800000, 0x27800000
.long 0x0, 0x1, 0x3f800000, 0x3f800000
.long 0x0, 0x1, 0x3f800000, 0x3f800000
.long 0x0, 0x0, 0x0, 0x27400
.long 0x8, 0x38, 0x1c, 0x27400
.long 0x10, 0x70, 0x38, 0x27400
.long 0x18, 0xa8, 0x54, 0x27400
.long 0x38, 0xe0, 0x70, 0x27400
.long 0x40, 0x118, 0x8c, 0x27400
.long 0x48, 0x150, 0xa8, 0x27400
.long 0x50, 0x188, 0xc4, 0x27400
.long 0x70, 0x1c0, 0xe0, 0x27400
.long 0x78, 0x1f8, 0xfc, 0x27400
.long 0x80, 0x230, 0x118, 0x27400
.long 0x88, 0x268, 0x134, 0x27400
.long 0xa8, 0x2a0, 0x150, 0x27400
.long 0xb0, 0x2d8, 0x16c, 0x27400
.long 0xb8, 0x310, 0x188, 0x27400
.long 0xc0, 0x348, 0x1a4, 0x27400
.long 0x20, 0x380, 0x1c0, 0x27400
.long 0x28, 0x3b8, 0x1dc, 0x27400
.long 0x28, 0x3f0, 0x1f8, 0x27400
.long 0x28, 0x428, 0x214, 0x27400
.long 0x58, 0x460, 0x230, 0x27400
.long 0x60, 0x498, 0x24c, 0x27400
.long 0x60, 0x4d0, 0x268, 0x27400
.long 0x60, 0x508, 0x284, 0x27400
.long 0x90, 0x540, 0x2a0, 0x27400
.long 0x98, 0x578, 0x2bc, 0x27400
.long 0x98, 0x5b0, 0x2d8, 0x27400
.long 0x98, 0x5e8, 0x2f4, 0x27400
.long 0xc8, 0x620, 0x310, 0x27400
.long 0xd0, 0x658, 0x32c, 0x27400
.long 0xd0, 0x690, 0x348, 0x27400
.long 0xd0, 0x6c8, 0x364, 0x27400
.long 0xe0, 0x4, 0x380, 0x27460
.long 0xe8, 0x3c, 0x39c, 0x27460
.long 0xf0, 0x74, 0x3b8, 0x27460
.long 0xf8, 0xac, 0x3d4, 0x27460
.long 0x118, 0xe4, 0x3f0, 0x27460
.long 0x120, 0x11c, 0x40c, 0x27460
.long 0x128, 0x154, 0x428, 0x27460
.long 0x130, 0x18c, 0x444, 0x27460
.long 0x150, 0x1c4, 0x460, 0x27460
.long 0x158, 0x1fc, 0x47c, 0x27460
.long 0x160, 0x234, 0x498, 0x27460
.long 0x168, 0x26c, 0x4b4, 0x27460
.long 0x188, 0x2a4, 0x4d0, 0x27460
.long 0x190, 0x2dc, 0x4ec, 0x27460
.long 0x198, 0x314, 0x508, 0x27460
.long 0x1a0, 0x34c, 0x524, 0x27460
.long 0x100, 0x384, 0x540, 0x27460
.long 0x108, 0x3bc, 0x55c, 0x27460
.long 0x108, 0x3f4, 0x578, 0x27460
.long 0x108, 0x42c, 0x594, 0x27460
.long 0x138, 0x464, 0x5b0, 0x27460
.long 0x140, 0x49c, 0x5cc, 0x27460
.long 0x140, 0x4d4, 0x5e8, 0x27460
.long 0x140, 0x50c, 0x604, 0x27460
.long 0x170, 0x544, 0x620, 0x27460
.long 0x178, 0x57c, 0x63c, 0x27460
.long 0x178, 0x5b4, 0x658, 0x27460
.long 0x178, 0x5ec, 0x674, 0x27460
.long 0x1a8, 0x624, 0x690, 0x27460
.long 0x1b0, 0x65c, 0x6ac, 0x27460
.long 0x1b0, 0x694, 0x6c8, 0x27460
.long 0x1b0, 0x6cc, 0x6e4, 0x27460
.long 0x0, 0x0, 0xbf800000, 0x17000
.long 0x0, 0x0, 0xbf800000, 0x17004
.long 0x0, 0x0, 0xbf800000, 0x17008
.long 0x0, 0x0, 0xbf800000, 0x1700c
.long 0x0, 0x0, 0xbf800000, 0x17010
.long 0x0, 0x0, 0xbf800000, 0x17014
.long 0x0, 0x0, 0xbf800000, 0x17018
.long 0x0, 0x0, 0xbf800000, 0x1701c
.long 0x0, 0x0, 0xbf800000, 0x17020
.long 0x0, 0x0, 0xbf800000, 0x17024
.long 0x0, 0x0, 0xbf800000, 0x17028
.long 0x0, 0x0, 0xbf800000, 0x1702c
.long 0x0, 0x0, 0xbf800000, 0x17030
.long 0x0, 0x0, 0xbf800000, 0x17034
.long 0x0, 0x0, 0xbf800000, 0x17038
.long 0x0, 0x0, 0xbf800000, 0x1703c
.long 0x0, 0x0, 0xbf800000, 0x17002
.long 0x0, 0x0, 0xbf800000, 0x17006
.long 0x0, 0x0, 0xbf800000, 0x1700a
.long 0x0, 0x0, 0xbf800000, 0x1700e
.long 0x0, 0x0, 0xbf800000, 0x17012
.long 0x0, 0x0, 0xbf800000, 0x17016
.long 0x0, 0x0, 0xbf800000, 0x1701a
.long 0x0, 0x0, 0xbf800000, 0x1701e
.long 0x0, 0x0, 0xbf800000, 0x17022
.long 0x0, 0x0, 0xbf800000, 0x17026
.long 0x0, 0x0, 0xbf800000, 0x1702a
.long 0x0, 0x0, 0xbf800000, 0x1702e
.long 0x0, 0x0, 0xbf800000, 0x17032
.long 0x0, 0x0, 0xbf800000, 0x17036
.long 0x0, 0x0, 0xbf800000, 0x1703a
.long 0x0, 0x0, 0xbf800000, 0x1703e
.long 0x4, 0x3f800000, 0x0, 0x17080
.long 0x4, 0x3f800000, 0x0, 0x17084
.long 0x4, 0x3f800000, 0x0, 0x17088
.long 0x4, 0x3f800000, 0x0, 0x1708c
.long 0x4, 0x3f800000, 0x0, 0x17090
.long 0x4, 0x3f800000, 0x0, 0x17094
.long 0x4, 0x3f800000, 0x0, 0x17098
.long 0x4, 0x3f800000, 0x0, 0x1709c
.long 0x4, 0x3f800000, 0x0, 0x170a0
.long 0x4, 0x3f800000, 0x0, 0x170a4
.long 0x4, 0x3f800000, 0x0, 0x170a8
.long 0x4, 0x3f800000, 0x0, 0x170ac
.long 0x4, 0x3f800000, 0x0, 0x170b0
.long 0x4, 0x3f800000, 0x0, 0x170b4
.long 0x4, 0x3f800000, 0x0, 0x170b8
.long 0x4, 0x3f800000, 0x0, 0x170bc
.long 0x4, 0x3f800000, 0x0, 0x17082
.long 0x4, 0x3f800000, 0x0, 0x17086
.long 0x4, 0x3f800000, 0x0, 0x1708a
.long 0x4, 0x3f800000, 0x0, 0x1708e
.long 0x4, 0x3f800000, 0x0, 0x17092
.long 0x4, 0x3f800000, 0x0, 0x17096
.long 0x4, 0x3f800000, 0x0, 0x1709a
.long 0x4, 0x3f800000, 0x0, 0x1709e
.long 0x4, 0x3f800000, 0x0, 0x170a2
.long 0x4, 0x3f800000, 0x0, 0x170a6
.long 0x4, 0x3f800000, 0x0, 0x170aa
.long 0x4, 0x3f800000, 0x0, 0x170ae
.long 0x4, 0x3f800000, 0x0, 0x170b2
.long 0x4, 0x3f800000, 0x0, 0x170b6
.long 0x4, 0x3f800000, 0x0, 0x170ba
.long 0x4, 0x3f800000, 0x0, 0x170be
.long 0x3f80, 0x0, 0x0, 0x0
.long 0x0, 0x3f80, 0x0, 0x0
.long 0x0, 0x0, 0x3f80, 0x0
.long 0x0, 0x0, 0x0, 0x3f80
.long 0x0, 0x0, 0x0, 0x0
.long 0x0, 0x0, 0x0, 0x0
.long 0x0, 0x0, 0x0, 0x0
.long 0x0, 0x0, 0x0, 0x0
.long 0x0, 0x0, 0x0, 0x0
.long 0x0, 0x0, 0x0, 0x0
.long 0x0, 0x0, 0x0, 0x0
.long 0x0, 0x0, 0x0, 0x0
.long 0x0, 0x0, 0x0, 0x0
.long 0x0, 0x0, 0x0, 0x0
.long 0x0, 0x0, 0x0, 0x0
.long 0x0, 0x0, 0x0, 0x0
.long 0x3f800000, 0x0, 0x0, 0x0
.long 0x0, 0x3f800000, 0x0, 0x0
.long 0x0, 0x0, 0x3f800000, 0x0
.long 0x0, 0x0, 0x0, 0x3f800000
.long 0x0, 0x0, 0x0, 0x0
.long 0x0, 0x0, 0x0, 0x0
.long 0x0, 0x0, 0x0, 0x0
.long 0x0, 0x0, 0x0, 0x0
.long 0x0, 0x0, 0x0, 0x0
.long 0x0, 0x0, 0x0, 0x0
.long 0x0, 0x0, 0x0, 0x0
.long 0x0, 0x0, 0x0, 0x0
.long 0x0, 0x0, 0x0, 0x0
.long 0x0, 0x0, 0x0, 0x0
.long 0x0, 0x0, 0x0, 0x0
.long 0x0, 0x0, 0x0, 0x0
.long 0x0, 0x0, 0x0, 0x0
.long 0x0, 0x0, 0x0, 0x0
.long 0x0, 0x0, 0x0, 0x0
.long 0x0, 0x0, 0x0, 0x0
.long 0x3f80, 0x0, 0x0, 0x0
.long 0x0, 0x3f80, 0x0, 0x0
.long 0x0, 0x0, 0x3f80, 0x0
.long 0x0, 0x0, 0x0, 0x3f80
.long 0x0, 0x0, 0x0, 0x0
.long 0x0, 0x0, 0x0, 0x0
.long 0x0, 0x0, 0x0, 0x0
.long 0x0, 0x0, 0x0, 0x0
.long 0x0, 0x0, 0x0, 0x0
.long 0x0, 0x0, 0x0, 0x0
.long 0x0, 0x0, 0x0, 0x0
.long 0x0, 0x0, 0x0, 0x0
.long 0x0, 0x0, 0x0, 0x0
.long 0x0, 0x0, 0x0, 0x0
.long 0x0, 0x0, 0x0, 0x0
.long 0x0, 0x0, 0x0, 0x0
.long 0x3f800000, 0x0, 0x0, 0x0
.long 0x0, 0x3f800000, 0x0, 0x0
.long 0x0, 0x0, 0x3f800000, 0x0
.long 0x0, 0x0, 0x0, 0x3f800000
.long 0x0, 0x0, 0x0, 0x0
.long 0x0, 0x0, 0x0, 0x0
.long 0x0, 0x0, 0x0, 0x0
.long 0x0, 0x0, 0x0, 0x0
.long 0x0, 0x0, 0x0, 0x0
.long 0x0, 0x0, 0x0, 0x0
.long 0x0, 0x0, 0x0, 0x0
.long 0x0, 0x0, 0x0, 0x0
.long 0x0, 0x0, 0x0, 0x0
.long 0x0, 0x0, 0x0, 0x0
.long 0x0, 0x0, 0x0, 0x0
.long 0x0, 0x0, 0x0, 0x0
.long 0x0, 0x0, 0x0, 0x0
.long 0x0, 0x0, 0x0, 0x0
.long 0x0, 0x0, 0x0, 0x0
.long 0x0, 0x0, 0x0, 0x0
.long 0x3f80, 0x0, 0x0, 0x0
.long 0x0, 0x3f80, 0x0, 0x0
.long 0x0, 0x0, 0x3f80, 0x0
.long 0x0, 0x0, 0x0, 0x3f80
.long 0x0, 0x0, 0x0, 0x0
.long 0x0, 0x0, 0x0, 0x0
.long 0x0, 0x0, 0x0, 0x0
.long 0x0, 0x0, 0x0, 0x0
.long 0x0, 0x0, 0x0, 0x0
.long 0x0, 0x0, 0x0, 0x0
.long 0x0, 0x0, 0x0, 0x0
.long 0x0, 0x0, 0x0, 0x0
.long 0x0, 0x0, 0x0, 0x0
.long 0x0, 0x0, 0x0, 0x0
.long 0x0, 0x0, 0x0, 0x0
.long 0x0, 0x0, 0x0, 0x0
.long 0x3f800000, 0x0, 0x0, 0x0
.long 0x0, 0x3f800000, 0x0, 0x0
.long 0x0, 0x0, 0x3f800000, 0x0
.long 0x0, 0x0, 0x0, 0x3f800000
.long 0x0, 0x0, 0x0, 0x0
.long 0x0, 0x0, 0x0, 0x0
.long 0x0, 0x0, 0x0, 0x0
.long 0x0, 0x0, 0x0, 0x0
.long 0x0, 0x0, 0x0, 0x0
.long 0x0, 0x0, 0x0, 0x0
.long 0x0, 0x0, 0x0, 0x0
.long 0x0, 0x0, 0x0, 0x0
.long 0x0, 0x0, 0x0, 0x0
.long 0x0, 0x0, 0x0, 0x0
.long 0x0, 0x0, 0x0, 0x0
.long 0x0, 0x0, 0x0, 0x0
.long 0x0, 0x0, 0x0, 0x0
.long 0x0, 0x0, 0x0, 0x0
.long 0x0, 0x0, 0x0, 0x0
.long 0x0, 0x0, 0x0, 0x0
.long 0x3f80, 0x0, 0x0, 0x0
.long 0x0, 0x3f80, 0x0, 0x0
.long 0x0, 0x0, 0x3f80, 0x0
.long 0x0, 0x0, 0x0, 0x3f80
.long 0x0, 0x0, 0x0, 0x0
.long 0x0, 0x0, 0x0, 0x0
.long 0x0, 0x0, 0x0, 0x0
.long 0x0, 0x0, 0x0, 0x0
.long 0x0, 0x0, 0x0, 0x0
.long 0x0, 0x0, 0x0, 0x0
.long 0x0, 0x0, 0x0, 0x0
.long 0x0, 0x0, 0x0, 0x0
.long 0x0, 0x0, 0x0, 0x0
.long 0x0, 0x0, 0x0, 0x0
.long 0x0, 0x0, 0x0, 0x0
.long 0x0, 0x0, 0x0, 0x0
.long 0x3f800000, 0x0, 0x0, 0x0
.long 0x0, 0x3f800000, 0x0, 0x0
.long 0x0, 0x0, 0x3f800000, 0x0
.long 0x0, 0x0, 0x0, 0x3f800000
.long 0x20, 0x20, 0x0, 0x0
.long 0x20, 0x20, 0x0, 0x10
.long 0x20, 0x60, 0x0, 0x20
.long 0x20, 0x60, 0x0, 0x30
.long 0x20, 0xa0, 0x0, 0x40
.long 0x20, 0xa0, 0x0, 0x50
.long 0x20, 0xe0, 0x0, 0x60
.long 0x20, 0xe0, 0x0, 0x70
.long 0x20, 0x20, 0x10, 0x0
.long 0x20, 0x20, 0x10, 0x10
.long 0x20, 0x60, 0x10, 0x20
.long 0x20, 0x60, 0x10, 0x30
.long 0x20, 0xa0, 0x10, 0x40
.long 0x20, 0xa0, 0x10, 0x50
.long 0x20, 0xe0, 0x10, 0x60
.long 0x20, 0xe0, 0x10, 0x70
.long 0x60, 0x20, 0x20, 0x0
.long 0x60, 0x20, 0x20, 0x10
.long 0x60, 0x60, 0x20, 0x20
.long 0x60, 0x60, 0x20, 0x30
.long 0x60, 0xa0, 0x20, 0x40
.long 0x60, 0xa0, 0x20, 0x50
.long 0x60, 0xe0, 0x20, 0x60
.long 0x60, 0xe0, 0x20, 0x70
.long 0x60, 0x20, 0x30, 0x0
.long 0x60, 0x20, 0x30, 0x10
.long 0x60, 0x60, 0x30, 0x20
.long 0x60, 0x60, 0x30, 0x30
.long 0x60, 0xa0, 0x30, 0x40
.long 0x60, 0xa0, 0x30, 0x50
.long 0x60, 0xe0, 0x30, 0x60
.long 0x60, 0xe0, 0x30, 0x70
.long 0xa0, 0x20, 0x40, 0x0
.long 0xa0, 0x20, 0x40, 0x10
.long 0xa0, 0x60, 0x40, 0x20
.long 0xa0, 0x60, 0x40, 0x30
.long 0xa0, 0xa0, 0x40, 0x40
.long 0xa0, 0xa0, 0x40, 0x50
.long 0xa0, 0xe0, 0x40, 0x60
.long 0xa0, 0xe0, 0x40, 0x70
.long 0xa0, 0x20, 0x50, 0x0
.long 0xa0, 0x20, 0x50, 0x10
.long 0xa0, 0x60, 0x50, 0x20
.long 0xa0, 0x60, 0x50, 0x30
.long 0xa0, 0xa0, 0x50, 0x40
.long 0xa0, 0xa0, 0x50, 0x50
.long 0xa0, 0xe0, 0x50, 0x60
.long 0xa0, 0xe0, 0x50, 0x70
.long 0xe0, 0x20, 0x60, 0x0
.long 0xe0, 0x20, 0x60, 0x10
.long 0xe0, 0x60, 0x60, 0x20
.long 0xe0, 0x60, 0x60, 0x30
.long 0xe0, 0xa0, 0x60, 0x40
.long 0xe0, 0xa0, 0x60, 0x50
.long 0xe0, 0xe0, 0x60, 0x60
.long 0xe0, 0xe0, 0x60, 0x70
.long 0xe0, 0x20, 0x70, 0x0
.long 0xe0, 0x20, 0x70, 0x10
.long 0xe0, 0x60, 0x70, 0x20
.long 0xe0, 0x60, 0x70, 0x30
.long 0xe0, 0xa0, 0x70, 0x40
.long 0xe0, 0xa0, 0x70, 0x50
.long 0xe0, 0xe0, 0x70, 0x60
.long 0xe0, 0xe0, 0x70, 0x70
.long 0x0, 0x0, 0x6000600, 0xa080200
.long 0x0, 0x1, 0x6000600, 0x1a181210
.long 0x0, 0x2, 0x6000600, 0x2a282220
.long 0x0, 0x3, 0x6000600, 0x3a383230
.long 0x0, 0x4, 0x6000600, 0xa080200
.long 0x0, 0x5, 0x6000600, 0x1a181210
.long 0x0, 0x6, 0x6000600, 0x2a282220
.long 0x0, 0x7, 0x6000600, 0x3a383230
.long 0x1, 0x0, 0x1800180, 0xa080200
.long 0x1, 0x1, 0xffffffff, 0x1a181210
.long 0x1, 0x2, 0xffffffff, 0x2a282220
.long 0x1, 0x3, 0xffffffff, 0x3a383230
.long 0x1, 0x4, 0xffffffff, 0xa080200
.long 0x1, 0x5, 0xffffffff, 0x1a181210
.long 0x1, 0x6, 0xffffffff, 0x2a282220
.long 0x1, 0x7, 0xffffffff, 0x3a383230
.long 0x2, 0x0, 0x6000600, 0xa080200
.long 0x2, 0x1, 0x6000600, 0x1a181210
.long 0x2, 0x2, 0x6000600, 0x2a282220
.long 0x2, 0x3, 0x6000600, 0x3a383230
.long 0x2, 0x4, 0x6000600, 0xa080200
.long 0x2, 0x5, 0x6000600, 0x1a181210
.long 0x2, 0x6, 0x6000600, 0x2a282220
.long 0x2, 0x7, 0x6000600, 0x3a383230
.long 0x3, 0x0, 0x1800180, 0xa080200
.long 0x3, 0x1, 0xffffffff, 0x1a181210
.long 0x3, 0x2, 0xffffffff, 0x2a282220
.long 0x3, 0x3, 0xffffffff, 0x3a383230
.long 0x3, 0x4, 0xffffffff, 0xa080200
.long 0x3, 0x5, 0xffffffff, 0x1a181210
.long 0x3, 0x6, 0xffffffff, 0x2a282220
.long 0x3, 0x7, 0xffffffff, 0x3a383230
.long 0x4, 0x0, 0x6000600, 0xa080200
.long 0x4, 0x1, 0x6000600, 0x1a181210
.long 0x4, 0x2, 0x6000600, 0x2a282220
.long 0x4, 0x3, 0x6000600, 0x3a383230
.long 0x4, 0x4, 0x6000600, 0xa080200
.long 0x4, 0x5, 0x6000600, 0x1a181210
.long 0x4, 0x6, 0x6000600, 0x2a282220
.long 0x4, 0x7, 0x6000600, 0x3a383230
.long 0x5, 0x0, 0x1800180, 0xa080200
.long 0x5, 0x1, 0xffffffff, 0x1a181210
.long 0x5, 0x2, 0xffffffff, 0x2a282220
.long 0x5, 0x3, 0xffffffff, 0x3a383230
.long 0x5, 0x4, 0xffffffff, 0xa080200
.long 0x5, 0x5, 0xffffffff, 0x1a181210
.long 0x5, 0x6, 0xffffffff, 0x2a282220
.long 0x5, 0x7, 0xffffffff, 0x3a383230
.long 0x6, 0x0, 0x6000600, 0xa080200
.long 0x6, 0x1, 0x6000600, 0x1a181210
.long 0x6, 0x2, 0x6000600, 0x2a282220
.long 0x6, 0x3, 0x6000600, 0x3a383230
.long 0x6, 0x4, 0x6000600, 0xa080200
.long 0x6, 0x5, 0x6000600, 0x1a181210
.long 0x6, 0x6, 0x6000600, 0x2a282220
.long 0x6, 0x7, 0x6000600, 0x3a383230
.long 0x7, 0x0, 0x1800180, 0xa080200
.long 0x7, 0x1, 0xffffffff, 0x1a181210
.long 0x7, 0x2, 0xffffffff, 0x2a282220
.long 0x7, 0x3, 0xffffffff, 0x3a383230
.long 0x7, 0x4, 0xffffffff, 0xa080200
.long 0x7, 0x5, 0xffffffff, 0x1a181210
.long 0x7, 0x6, 0xffffffff, 0x2a282220
.long 0x7, 0x7, 0xffffffff, 0x3a383230
.long 0x0, 0x0, 0x0, 0x0
.long 0x2, 0x1, 0x4, 0x10
.long 0x4, 0x2, 0x8, 0x20
.long 0x6, 0x3, 0xc, 0x30
.long 0x8, 0x3, 0x10, 0x40
.long 0xa, 0x4, 0x14, 0x50
.long 0xc, 0x5, 0x18, 0x60
.long 0xe, 0x6, 0x1c, 0x70
.long 0x10, 0x6, 0x20, 0x80
.long 0x12, 0x7, 0x24, 0x90
.long 0x14, 0x8, 0x28, 0xa0
.long 0x16, 0x9, 0x2c, 0xb0
.long 0x18, 0x9, 0x30, 0xc0
.long 0x1a, 0xa, 0x34, 0xd0
.long 0x1c, 0xb, 0x38, 0xe0
.long 0x1e, 0xc, 0x3c, 0xf0
.long 0x20, 0xc, 0x40, 0x100
.long 0x22, 0xd, 0x44, 0x110
.long 0x24, 0xe, 0x48, 0x120
.long 0x26, 0xf, 0x4c, 0x130
.long 0x28, 0xf, 0x50, 0x140
.long 0x2a, 0x10, 0x54, 0x150
.long 0x2c, 0x11, 0x58, 0x160
.long 0x2e, 0x12, 0x5c, 0x170
.long 0x30, 0x12, 0x60, 0x180
.long 0x32, 0x13, 0x64, 0x190
.long 0x34, 0x14, 0x68, 0x1a0
.long 0x36, 0x15, 0x6c, 0x1b0
.long 0x38, 0x15, 0x70, 0x1c0
.long 0x3a, 0x16, 0x74, 0x1d0
.long 0x3c, 0x17, 0x78, 0x1e0
.long 0x3e, 0x18, 0x7c, 0x1f0
.long 0x80, 0x0, 0x80, 0x200
.long 0x82, 0x1, 0x84, 0x210
.long 0x84, 0x2, 0x88, 0x220
.long 0x86, 0x3, 0x8c, 0x230
.long 0x88, 0x3, 0x90, 0x240
.long 0x8a, 0x4, 0x94, 0x250
.long 0x8c, 0x5, 0x98, 0x260
.long 0x8e, 0x6, 0x9c, 0x270
.long 0x90, 0x6, 0xa0, 0x280
.long 0x92, 0x7, 0xa4, 0x290
.long 0x94, 0x8, 0xa8, 0x2a0
.long 0x96, 0x9, 0xac, 0x2b0
.long 0x98, 0x9, 0xb0, 0x2c0
.long 0x9a, 0xa, 0xb4, 0x2d0
.long 0x9c, 0xb, 0xb8, 0x2e0
.long 0x9e, 0xc, 0xbc, 0x2f0
.long 0xa0, 0xc, 0xc0, 0x300
.long 0xa2, 0xd, 0xc4, 0x310
.long 0xa4, 0xe, 0xc8, 0x320
.long 0xa6, 0xf, 0xcc, 0x330
.long 0xa8, 0xf, 0xd0, 0x340
.long 0xaa, 0x10, 0xd4, 0x350
.long 0xac, 0x11, 0xd8, 0x360
.long 0xae, 0x12, 0xdc, 0x370
.long 0xb0, 0x12, 0xe0, 0x380
.long 0xb2, 0x13, 0xe4, 0x390
.long 0xb4, 0x14, 0xe8, 0x3a0
.long 0xb6, 0x15, 0xec, 0x3b0
.long 0xb8, 0x15, 0xf0, 0x3c0
.long 0xba, 0x16, 0xf4, 0x3d0
.long 0xbc, 0x17, 0xf8, 0x3e0
.long 0xbe, 0x18, 0xfc, 0x3f0
.long 0x0, 0x0, 0x20, 0x0
.long 0x10, 0x4, 0x60, 0x40
.long 0x20, 0x8, 0xa0, 0x80
.long 0x30, 0xc, 0xe0, 0xc0
.long 0x0, 0x0, 0x20, 0x0
.long 0x10, 0x4, 0x60, 0x40
.long 0x20, 0x8, 0xa0, 0x80
.long 0x30, 0xc, 0xe0, 0xc0
.long 0x0, 0x0, 0x20, 0x0
.long 0x10, 0x4, 0x60, 0x40
.long 0x20, 0x8, 0xa0, 0x80
.long 0x30, 0xc, 0xe0, 0xc0
.long 0x0, 0x0, 0x20, 0x0
.long 0x10, 0x4, 0x60, 0x40
.long 0x20, 0x8, 0xa0, 0x80
.long 0x30, 0xc, 0xe0, 0xc0
.long 0x0, 0x0, 0x20, 0x0
.long 0x10, 0x4, 0x60, 0x40
.long 0x20, 0x8, 0xa0, 0x80
.long 0x30, 0xc, 0xe0, 0xc0
.long 0x0, 0x0, 0x20, 0x0
.long 0x10, 0x4, 0x60, 0x40
.long 0x20, 0x8, 0xa0, 0x80
.long 0x30, 0xc, 0xe0, 0xc0
.long 0x0, 0x0, 0x20, 0x0
.long 0x10, 0x4, 0x60, 0x40
.long 0x20, 0x8, 0xa0, 0x80
.long 0x30, 0xc, 0xe0, 0xc0
.long 0x0, 0x0, 0x20, 0x0
.long 0x10, 0x4, 0x60, 0x40
.long 0x20, 0x8, 0xa0, 0x80
.long 0x30, 0xc, 0xe0, 0xc0
.long 0x0, 0x0, 0x20, 0x0
.long 0x10, 0x4, 0x60, 0x40
.long 0x20, 0x8, 0xa0, 0x80
.long 0x30, 0xc, 0xe0, 0xc0
.long 0x0, 0x0, 0x20, 0x0
.long 0x10, 0x4, 0x60, 0x40
.long 0x20, 0x8, 0xa0, 0x80
.long 0x30, 0xc, 0xe0, 0xc0
.long 0x0, 0x0, 0x20, 0x0
.long 0x10, 0x4, 0x60, 0x40
.long 0x20, 0x8, 0xa0, 0x80
.long 0x30, 0xc, 0xe0, 0xc0
.long 0x0, 0x0, 0x20, 0x0
.long 0x10, 0x4, 0x60, 0x40
.long 0x20, 0x8, 0xa0, 0x80
.long 0x30, 0xc, 0xe0, 0xc0
.long 0x0, 0x0, 0x20, 0x0
.long 0x10, 0x4, 0x60, 0x40
.long 0x20, 0x8, 0xa0, 0x80
.long 0x30, 0xc, 0xe0, 0xc0
.long 0x0, 0x0, 0x20, 0x0
.long 0x10, 0x4, 0x60, 0x40
.long 0x20, 0x8, 0xa0, 0x80
.long 0x30, 0xc, 0xe0, 0xc0
.long 0x0, 0x0, 0x20, 0x0
.long 0x10, 0x4, 0x60, 0x40
.long 0x20, 0x8, 0xa0, 0x80
.long 0x30, 0xc, 0xe0, 0xc0
.long 0x0, 0x0, 0x20, 0x0
.long 0x10, 0x4, 0x60, 0x40
.long 0x20, 0x8, 0xa0, 0x80
.long 0x30, 0xc, 0xe0, 0xc0
.long 0x0, 0xc010c00, 0x27400, 0x0
.long 0x0, 0xc030c02, 0x27410, 0x6
.long 0x0, 0xc050c04, 0x27420, 0xc
.long 0x0, 0xc070c06, 0x27430, 0x12
.long 0x8, 0xc010c00, 0x27440, 0x18
.long 0x8, 0xc030c02, 0x27450, 0x1e
.long 0x8, 0xc050c04, 0x27460, 0x24
.long 0x8, 0xc070c06, 0x27470, 0x2a
.long 0x10, 0xc010c00, 0x27480, 0x30
.long 0x10, 0xc030c02, 0x27490, 0x36
.long 0x10, 0xc050c04, 0x274a0, 0x3c
.long 0x10, 0xc070c06, 0x274b0, 0x42
.long 0x18, 0xc010c00, 0x274c0, 0x48
.long 0x18, 0xc030c02, 0x274d0, 0x4e
.long 0x18, 0xc050c04, 0x274e0, 0x54
.long 0x18, 0xc070c06, 0x274f0, 0x5a
.long 0x1, 0xc010c00, 0x27500, 0x60
.long 0x1, 0xc030c02, 0x27510, 0x66
.long 0x1, 0xc050c04, 0x27520, 0x6c
.long 0x1, 0xc070c06, 0x27530, 0x72
.long 0x9, 0xc010c00, 0x27540, 0x78
.long 0x9, 0xc030c02, 0x27550, 0x7e
.long 0x9, 0xc050c04, 0x27560, 0x84
.long 0x9, 0xc070c06, 0x27570, 0x8a
.long 0x11, 0xc010c00, 0x27580, 0x90
.long 0x11, 0xc030c02, 0x27590, 0x96
.long 0x11, 0xc050c04, 0x275a0, 0x9c
.long 0x11, 0xc070c06, 0x275b0, 0xa2
.long 0x19, 0xc010c00, 0x275c0, 0xa8
.long 0x19, 0xc030c02, 0x275d0, 0xae
.long 0x19, 0xc050c04, 0x275e0, 0xb4
.long 0x19, 0xc070c06, 0x275f0, 0xba
.long 0x2, 0xc010c00, 0x27460, 0x4
.long 0x2, 0xc030c02, 0x27470, 0xa
.long 0x2, 0xc050c04, 0x27480, 0x10
.long 0x2, 0xc070c06, 0x27490, 0x16
.long 0xa, 0xc010c00, 0x274a0, 0x1c
.long 0xa, 0xc030c02, 0x274b0, 0x22
.long 0xa, 0xc050c04, 0x274c0, 0x28
.long 0xa, 0xc070c06, 0x274d0, 0x2e
.long 0x12, 0xc010c00, 0x274e0, 0x34
.long 0x12, 0xc030c02, 0x274f0, 0x3a
.long 0x12, 0xc050c04, 0x27500, 0x40
.long 0x12, 0xc070c06, 0x27510, 0x46
.long 0x1a, 0xc010c00, 0x27520, 0x4c
.long 0x1a, 0xc030c02, 0x27530, 0x52
.long 0x1a, 0xc050c04, 0x27540, 0x58
.long 0x1a, 0xc070c06, 0x27550, 0x5e
.long 0x3, 0xc010c00, 0x27560, 0x64
.long 0x3, 0xc030c02, 0x27570, 0x6a
.long 0x3, 0xc050c04, 0x27580, 0x70
.long 0x3, 0xc070c06, 0x27590, 0x76
.long 0xb, 0xc010c00, 0x275a0, 0x7c
.long 0xb, 0xc030c02, 0x275b0, 0x82
.long 0xb, 0xc050c04, 0x275c0, 0x88
.long 0xb, 0xc070c06, 0x275d0, 0x8e
.long 0x13, 0xc010c00, 0x275e0, 0x94
.long 0x13, 0xc030c02, 0x275f0, 0x9a
.long 0x13, 0xc050c04, 0x27600, 0xa0
.long 0x13, 0xc070c06, 0x27610, 0xa6
.long 0x1b, 0xc010c00, 0x27620, 0xac
.long 0x1b, 0xc030c02, 0x27630, 0xb2
.long 0x1b, 0xc050c04, 0x27640, 0xb8
.long 0x1b, 0xc070c06, 0x27650, 0xbe
.long 0x3f80, 0x0, 0x0, 0x0
.long 0x0, 0x0, 0x0, 0x0
.long 0x3f800000, 0x0, 0x0, 0x0
.long 0x0, 0x0, 0x0, 0x0
.long 0x0, 0x3f800000, 0x0, 0x0
.long 0x0, 0x0, 0x0, 0x0
.long 0x0, 0x0, 0x0, 0x0
.long 0x0, 0x0, 0x0, 0x0
.long 0x0, 0x0, 0x0, 0x0
.long 0x0, 0x0, 0x0, 0x0
.long 0x0, 0x0, 0x0, 0x0
.long 0x0, 0x0, 0x0, 0x0
.long 0x0, 0x0, 0x0, 0x0
.long 0x0, 0x0, 0x0, 0x0
.long 0x0, 0x0, 0x0, 0x0
.long 0x0, 0x0, 0x0, 0x0
.long 0x0, 0x0, 0x0, 0x0
.long 0x0, 0x0, 0x0, 0x0
.long 0x0, 0x0, 0x0, 0x0
.long 0x0, 0x0, 0x0, 0x0
.long 0x0, 0x0, 0x0, 0x0
.long 0x0, 0x0, 0x0, 0x0
.long 0x0, 0x0, 0x0, 0x0
.long 0x0, 0x0, 0x0, 0x0
.long 0x0, 0x0, 0x0, 0x0
.long 0x0, 0x0, 0x0, 0x0
.long 0x0, 0x0, 0x0, 0x0
.long 0x0, 0x0, 0x0, 0x0
.long 0x0, 0x0, 0x0, 0x0
.long 0x0, 0x0, 0x0, 0x0
.long 0x0, 0x0, 0x0, 0x0
.long 0x0, 0x0, 0x0, 0x0
.long 0x0, 0x0, 0x0, 0x0
.long 0x3f80, 0x0, 0x0, 0x0
.long 0x0, 0x0, 0x0, 0x0
.long 0x3f800000, 0x0, 0x0, 0x0
.long 0x0, 0x0, 0x0, 0x0
.long 0x0, 0x3f800000, 0x0, 0x0
.long 0x0, 0x0, 0x0, 0x0
.long 0x0, 0x0, 0x0, 0x0
.long 0x0, 0x0, 0x0, 0x0
.long 0x0, 0x0, 0x0, 0x0
.long 0x0, 0x0, 0x0, 0x0
.long 0x0, 0x0, 0x0, 0x0
.long 0x0, 0x0, 0x0, 0x0
.long 0x0, 0x0, 0x0, 0x0
.long 0x0, 0x0, 0x0, 0x0
.long 0x0, 0x0, 0x0, 0x0
.long 0x0, 0x0, 0x0, 0x0
.long 0x0, 0x0, 0x0, 0x0
.long 0x0, 0x0, 0x0, 0x0
.long 0x0, 0x0, 0x0, 0x0
.long 0x0, 0x0, 0x0, 0x0
.long 0x0, 0x0, 0x0, 0x0
.long 0x0, 0x0, 0x0, 0x0
.long 0x0, 0x0, 0x0, 0x0
.long 0x0, 0x0, 0x0, 0x0
.long 0x0, 0x0, 0x0, 0x0
.long 0x0, 0x0, 0x0, 0x0
.long 0x0, 0x0, 0x0, 0x0
.long 0x0, 0x0, 0x0, 0x0
.long 0x0, 0x0, 0x0, 0x0
.long 0x0, 0x0, 0x0, 0x0
.long 0x0, 0x0, 0x0, 0x0
.long 0x1fc80, 0x1fc00, 0x19800, 0x1b800
.long 0x1fc88, 0x1fc02, 0x19808, 0x1b800
.long 0x1fc90, 0x1fc04, 0x19810, 0x1b800
.long 0x1fc98, 0x1fc06, 0x19818, 0x1b800
.long 0x1fd00, 0x1fc08, 0x19880, 0x1b800
.long 0x1fd08, 0x1fc0a, 0x19888, 0x1b800
.long 0x1fd10, 0x1fc0c, 0x19890, 0x1b800
.long 0x1fd18, 0x1fc0e, 0x19898, 0x1b800
.long 0x1fd80, 0x1fc10, 0x19900, 0x1b800
.long 0x1fd88, 0x1fc12, 0x19908, 0x1b800
.long 0x1fd90, 0x1fc14, 0x19910, 0x1b800
.long 0x1fd98, 0x1fc16, 0x19918, 0x1b800
.long 0x1fe00, 0x1fc18, 0x19980, 0x1b800
.long 0x1fe08, 0x1fc1a, 0x19988, 0x1b800
.long 0x1fe10, 0x1fc1c, 0x19990, 0x1b800
.long 0x1fe18, 0x1fc1e, 0x19998, 0x1b800
.long 0x1fcc0, 0x1fc40, 0x19820, 0x1b800
.long 0x1fcc8, 0x1fc42, 0x19828, 0x1b800
.long 0x1fcd0, 0x1fc44, 0x19830, 0x1b800
.long 0x1fcd8, 0x1fc46, 0x19838, 0x1b800
.long 0x1fd40, 0x1fc48, 0x198a0, 0x1b800
.long 0x1fd48, 0x1fc4a, 0x198a8, 0x1b800
.long 0x1fd50, 0x1fc4c, 0x198b0, 0x1b800
.long 0x1fd58, 0x1fc4e, 0x198b8, 0x1b800
.long 0x1fdc0, 0x1fc50, 0x19920, 0x1b800
.long 0x1fdc8, 0x1fc52, 0x19928, 0x1b800
.long 0x1fdd0, 0x1fc54, 0x19930, 0x1b800
.long 0x1fdd8, 0x1fc56, 0x19938, 0x1b800
.long 0x1fe40, 0x1fc58, 0x199a0, 0x1b800
.long 0x1fe48, 0x1fc5a, 0x199a8, 0x1b800
.long 0x1fe50, 0x1fc5c, 0x199b0, 0x1b800
.long 0x1fe58, 0x1fc5e, 0x199b8, 0x1b800
.long 0x20080, 0x1fc00, 0x19a00, 0x1b808
.long 0x20088, 0x1fc02, 0x19a08, 0x1b808
.long 0x20090, 0x1fc04, 0x19a10, 0x1b808
.long 0x20098, 0x1fc06, 0x19a18, 0x1b808
.long 0x20100, 0x1fc08, 0x19a80, 0x1b808
.long 0x20108, 0x1fc0a, 0x19a88, 0x1b808
.long 0x20110, 0x1fc0c, 0x19a90, 0x1b808
.long 0x20118, 0x1fc0e, 0x19a98, 0x1b808
.long 0x20180, 0x1fc10, 0x19b00, 0x1b808
.long 0x20188, 0x1fc12, 0x19b08, 0x1b808
.long 0x20190, 0x1fc14, 0x19b10, 0x1b808
.long 0x20198, 0x1fc16, 0x19b18, 0x1b808
.long 0x20200, 0x1fc18, 0x19b80, 0x1b808
.long 0x20208, 0x1fc1a, 0x19b88, 0x1b808
.long 0x20210, 0x1fc1c, 0x19b90, 0x1b808
.long 0x20218, 0x1fc1e, 0x19b98, 0x1b808
.long 0x200c0, 0x1fc40, 0x19a20, 0x1b808
.long 0x200c8, 0x1fc42, 0x19a28, 0x1b808
.long 0x200d0, 0x1fc44, 0x19a30, 0x1b808
.long 0x200d8, 0x1fc46, 0x19a38, 0x1b808
.long 0x20140, 0x1fc48, 0x19aa0, 0x1b808
.long 0x20148, 0x1fc4a, 0x19aa8, 0x1b808
.long 0x20150, 0x1fc4c, 0x19ab0, 0x1b808
.long 0x20158, 0x1fc4e, 0x19ab8, 0x1b808
.long 0x201c0, 0x1fc50, 0x19b20, 0x1b808
.long 0x201c8, 0x1fc52, 0x19b28, 0x1b808
.long 0x201d0, 0x1fc54, 0x19b30, 0x1b808
.long 0x201d8, 0x1fc56, 0x19b38, 0x1b808
.long 0x20240, 0x1fc58, 0x19ba0, 0x1b808
.long 0x20248, 0x1fc5a, 0x19ba8, 0x1b808
.long 0x20250, 0x1fc5c, 0x19bb0, 0x1b808
.long 0x20258, 0x1fc5e, 0x19bb8, 0x1b808
.size K_TAB, 16384
.section .rodata,"a"
.p2align 6
.amdhsa_kernel standalone__cheap_equivariant_egnn__graph_kernel
      .amdhsa_next_free_vgpr 256
      .amdhsa_next_free_sgpr 102
      .amdhsa_accum_offset 256
      .amdhsa_group_segment_fixed_size 0
      .amdhsa_kernarg_size 88
      .amdhsa_user_sgpr_count 2
      .amdhsa_user_sgpr_kernarg_segment_ptr 1
      .amdhsa_system_sgpr_workgroup_id_x 1
      .amdhsa_float_denorm_mode_32 3
.end_amdhsa_kernel
```
